```python
import torch

def _softmax(x, axis=-1):
    return torch.softmax(x, dim=axis)
def _gelu(x):
    return torch.nn.functional.gelu(x, approximate="tanh")
def _silu(x):
    return torch.nn.functional.silu(x)
def _sigmoid(x):
    return torch.sigmoid(x)
def _layernorm(x, axis=-1, eps=1e-5):
    m = x.mean(dim=axis, keepdim=True)
    v = x.var(dim=axis, keepdim=True, unbiased=False)
    return (x - m) / torch.sqrt(v + eps)
def _scatter_add(tgt, idx, src, axis=0):
    return tgt.clone().index_add_(axis, idx, src)
def _segment_sum(src, seg, n):
    out = torch.zeros((n,) + src.shape[1:], dtype=src.dtype)
    return out.index_add_(0, seg, src)
def _pad(x, pw):
    flat = tuple(v for pair in reversed(pw) for v in pair)
    return torch.nn.functional.pad(x, flat)

kernel_name = 'recurrent_scan__compressed_kv_cla__dense_activation_gelu__decode'

def setup_inputs():

    _w = (lambda a: (lambda t: t.to(torch.bfloat16) if t.is_floating_point() else t)(torch.as_tensor(a)))
    def _A_setup():
        B, H, Sq, Sk, D, M = 2, 32, 1, 16384, 128, 512
        Dc = 4 * D
        return {
            "x": _w((lambda *s: torch.randn(*s, dtype=torch.bfloat16) * 0.1)(B, Sq, M)),
            "c_kv": _w((lambda *s: torch.randn(*s, dtype=torch.bfloat16) * 3.2)(B, Sk, Dc)),
            "w_q": _w((lambda *s: torch.randn(*s, dtype=torch.bfloat16) * 0.8)(M, H, D) * (M ** -0.5)),
            "w_uk": _w((lambda *s: torch.randn(*s, dtype=torch.bfloat16) * 0.8)(Dc, H, D) * (Dc ** -0.5)),
            "w_uv": _w((lambda *s: torch.randn(*s, dtype=torch.bfloat16) * 3.2)(Dc, H, D) * (Dc ** -0.5)),
            "w_o": _w((lambda *s: torch.randn(*s, dtype=torch.bfloat16) * 3.2)(H, D, M) * ((H * D) ** -0.5)),
        }
    _A_in = _A_setup()

    def _B_setup():
        B, S, D, F = 2, 1, 512, 1792
        return {
            "x": _w((lambda *s: torch.randn(*s, dtype=torch.bfloat16) * 0.1)(B, S, D)),
            "w1": _w((lambda *s: torch.randn(*s, dtype=torch.bfloat16) * 3.2)(D, F) * (D ** -0.5)),
            "b1": _w((lambda *s: torch.randn(*s, dtype=torch.bfloat16) * 3.2)(F) * 0.01),
            "w2": _w((lambda *s: torch.randn(*s, dtype=torch.bfloat16) * 3.2)(F, D) * (F ** -0.5)),
            "b2": _w((lambda *s: torch.randn(*s, dtype=torch.bfloat16) * 3.2)(D) * 0.01),
        }
    _B_in = _B_setup()

    return {
        "A_x": _A_in["x"],
        "A_c_kv": _A_in["c_kv"],
        "A_w_q": _A_in["w_q"],
        "A_w_uk": _A_in["w_uk"],
        "A_w_uv": _A_in["w_uv"],
        "A_w_o": _A_in["w_o"],
        "B_x": _B_in["x"],
        "B_w1": _B_in["w1"],
        "B_b1": _B_in["b1"],
        "B_w2": _B_in["w2"],
        "B_b2": _B_in["b2"],
    }

def reference(A_x, A_c_kv, A_w_q, A_w_uk, A_w_uv, A_w_o, B_x, B_w1, B_b1, B_w2, B_b2):
    def _A_ref(x, c_kv, w_q, w_uk, w_uv, w_o):
        B, Sq, M = x.shape[0], x.shape[1], x.shape[2]
        Sk = c_kv.shape[1]
        H, D = w_q.shape[1], w_q.shape[2]
        q = torch.einsum("bqm,mhd->bhqd", x, w_q)
        k = torch.einsum("bkc,chd->bhkd", c_kv, w_uk)
        v = torch.einsum("bkc,chd->bhkd", c_kv, w_uv)
        scores = torch.einsum("bhqd,bhkd->bhqk", q, k) * (D ** -0.5)
        off = Sk - Sq
        qi = torch.arange(Sq)[:, None]
        kj = torch.arange(Sk)[None, :]
        cmask = kj <= (qi + off)
        scores = torch.where(cmask[None, None], scores, -1e9)
        p = _softmax(scores, axis=-1)
        ctx = torch.einsum("bhqk,bhkd->bhqd", p, v)
        return torch.einsum("bhqd,hdm->bqm", ctx, w_o)

    def _B_ref(x, w1, b1, w2, b2):
        h = torch.einsum("bsd,df->bsf", x, w1) + b1
        h = _gelu(h)
        return torch.einsum("bsf,fd->bsd", h, w2) + b2

    x = A_x
    xn = _layernorm(x, axis=-1)
    s = _A_ref(xn, A_c_kv, A_w_q, A_w_uk, A_w_uv, A_w_o)
    g = _silu(_B_ref(xn, B_w1, B_b1, B_w2, B_b2))
    return x + s * g
```

```asm
; @launch grid=(256,1,1) block=(512,1,1) lds=163840
.amdgcn_target "amdgcn-amd-amdhsa--gfx950"
.text
.globl recurrent_scan__compressed_kv_cla__dense_activation_gelu__decode_kernel
.p2align 8
.type recurrent_scan__compressed_kv_cla__dense_activation_gelu__decode_kernel,@function
recurrent_scan__compressed_kv_cla__dense_activation_gelu__decode_kernel:
    s_cmp_ge_u32 s2, 256
    s_cbranch_scc1 L_exit
    s_load_dwordx16 s[4:19], s[0:1], 0
    s_load_dwordx8 s[20:27], s[0:1], 64
    s_load_dwordx4 s[28:31], s[0:1], 96
    v_lshrrev_b32 v2, 6, v0
    v_and_b32 v1, 63, v0
    s_mov_b32 s62, 1000000
    v_readfirstlane_b32 s33, v2
    s_and_b32 s34, s2, 127
    s_and_b32 s35, s2, 7
    s_bfe_u32 s36, s2, 0x20005
    s_lshl_b32 s36, s36, 3
    s_or_b32 s35, s35, s36
    s_bfe_u32 s36, s2, 0x20003
    s_lshl_b32 s60, s33, 3
    s_lshl_b32 s61, s36, 1
    s_add_u32 s60, s60, s61
    s_lshr_b32 s61, s2, 7
    s_add_u32 s60, s60, s61
    s_lshl_b32 s60, s60, 16
    s_lshl_b32 s61, s35, 8
    s_add_u32 s60, s60, s61
    v_lshrrev_b32 v2, 1, v1
    v_and_b32 v3, 1, v1
    v_lshlrev_b32 v2, 13, v2
    v_lshl_add_u32 v2, v3, 7, v2
    v_add_u32 v4, s60, v2
    v_lshlrev_b32 v5, 4, v0
    s_lshr_b32 s61, s2, 6
    s_and_b32 s61, s61, 2
    s_add_u32 s61, s61, s33
    s_cmp_lt_u32 s61, 2
    s_waitcnt lgkmcnt(0)
    s_cbranch_scc0 L_nox
    global_load_dwordx4 v[128:131], v5, s[4:5]
L_nox:
    s_mov_b64 exec, 0xffff
    global_load_dword v255, v4, s[8:9]
    s_mov_b64 exec, -1
    v_lshrrev_b32 v2, 4, v1
    v_and_b32 v3, 15, v1
    s_add_u32 s40, s30, 0
    s_addc_u32 s41, s31, 0
    s_mov_b32 s42, 0x640000
    s_mov_b32 s43, 0x20000
    s_load_dword s32, s[40:41], 0
    s_cmp_lt_u32 s2, 128
    s_cbranch_scc1 L_svc
    s_cmp_ge_u32 s33, 4
    s_cbranch_scc1 L_pv0
    s_branch L_att
L_svc:
    s_and_b32 s35, s34, 7
    s_lshr_b32 s60, s34, 5
    s_lshl_b32 s60, s60, 3
    s_or_b32 s35, s35, s60
    s_bfe_u32 s36, s34, 0x20003
    s_mov_b32 s44, s8
    s_mov_b32 s45, s9
    s_mov_b32 s46, 0x400000
    s_mov_b32 s47, 0x20000
    s_mov_b32 s48, s10
    s_mov_b32 s49, s11
    s_mov_b32 s50, 0x400000
    s_mov_b32 s51, 0x20000
    s_mov_b32 s52, s4
    s_mov_b32 s53, s5
    s_mov_b32 s54, 0x800
    s_mov_b32 s55, 0x20000
    s_lshl_b32 s3, s35, 10
    s_lshl_b32 s60, s36, 8
    s_add_u32 s3, s3, s60
    s_add_u32 s3, s3, 65536
    v_lshlrev_b32 v6, 4, v3
    v_lshl_add_u32 v9, v2, 15, v6
    v_lshlrev_b32 v6, 1, v2
    v_xor_b32 v7, v6, v3
    v_lshlrev_b32 v7, 4, v7
    v_lshl_add_u32 v10, v2, 13, v7
    v_xor_b32 v11, 128, v10
    s_lshl_b32 s38, s33, 14
    s_add_u32 s38, s38, 16384
    s_lshl_b32 s39, s33, 19
    s_lshl_b32 s63, s35, 8
    s_add_u32 s39, s39, s63
    s_add_u32 s60, s36, 0
    s_and_b32 s60, s60, 3
    s_lshl_b32 s60, s60, 17
    s_add_u32 s56, s39, s60
    s_add_u32 s60, s36, 1
    s_and_b32 s60, s60, 3
    s_lshl_b32 s60, s60, 17
    s_add_u32 s57, s39, s60
    s_add_u32 s60, s36, 2
    s_and_b32 s60, s60, 3
    s_lshl_b32 s60, s60, 17
    s_add_u32 s58, s39, s60
    s_add_u32 s60, s36, 3
    s_and_b32 s60, s60, 3
    s_lshl_b32 s60, s60, 17
    s_add_u32 s59, s39, s60
    s_add_u32 s60, s56, 0
    s_add_u32 m0, s38, 0
    s_nop 0
    buffer_load_dwordx4 v10, s[44:47], s60 offen lds
    s_add_u32 s60, s56, 32768
    s_add_u32 m0, s38, 1024
    s_nop 0
    buffer_load_dwordx4 v10, s[44:47], s60 offen lds
    s_add_u32 s60, s56, 65536
    s_add_u32 m0, s38, 2048
    s_nop 0
    buffer_load_dwordx4 v11, s[44:47], s60 offen lds
    s_add_u32 s60, s56, 98304
    s_add_u32 m0, s38, 3072
    s_nop 0
    buffer_load_dwordx4 v11, s[44:47], s60 offen lds
    s_lshl_b32 s37, s36, 7
    s_lshl_b32 s60, s33, 4
    s_add_u32 s37, s37, s60
    s_lshl_b32 s37, s37, 13
    s_add_u32 s37, s37, s63
    v_lshlrev_b32 v6, 4, v2
    v_lshl_add_u32 v12, v3, 13, v6
    s_cmp_gt_u32 s33, 1
    s_cbranch_scc1 L_svc_fw
    s_waitcnt vmcnt(5)
    v_lshlrev_b32 v136, 16, v128
    v_and_b32 v137, 0xffff0000, v128
    v_lshlrev_b32 v138, 16, v129
    v_and_b32 v139, 0xffff0000, v129
    v_lshlrev_b32 v140, 16, v130
    v_and_b32 v141, 0xffff0000, v130
    v_lshlrev_b32 v142, 16, v131
    v_and_b32 v143, 0xffff0000, v131
    v_add_f32 v6, v136, v137
    v_add_f32 v7, v138, v139
    v_add_f32 v6, v6, v140
    v_add_f32 v7, v7, v141
    v_add_f32 v6, v6, v142
    v_add_f32 v7, v7, v143
    v_add_f32 v6, v6, v7
    s_nop 1
    v_add_f32_dpp v6, v6, v6 quad_perm:[1,0,3,2] row_mask:0xf bank_mask:0xf
    s_nop 1
    v_add_f32_dpp v6, v6, v6 quad_perm:[2,3,0,1] row_mask:0xf bank_mask:0xf
    s_nop 1
    v_add_f32_dpp v6, v6, v6 row_half_mirror row_mask:0xf bank_mask:0xf
    s_nop 1
    v_add_f32_dpp v6, v6, v6 row_mirror row_mask:0xf bank_mask:0xf
    v_mov_b32 v7, v6
    s_nop 1
    v_permlane16_swap_b32 v6, v7
    s_nop 0
    v_add_f32 v6, v6, v7
    v_mov_b32 v7, v6
    s_nop 1
    v_permlane32_swap_b32 v6, v7
    s_nop 0
    v_add_f32 v6, v6, v7
    v_mul_f32 v6, 0x3b000000, v6
    v_sub_f32 v144, v136, v6
    v_sub_f32 v145, v137, v6
    v_sub_f32 v146, v138, v6
    v_sub_f32 v147, v139, v6
    v_sub_f32 v148, v140, v6
    v_sub_f32 v149, v141, v6
    v_sub_f32 v150, v142, v6
    v_sub_f32 v151, v143, v6
    v_mul_f32 v8, v144, v144
    v_fmac_f32 v8, v145, v145
    v_fmac_f32 v8, v146, v146
    v_fmac_f32 v8, v147, v147
    v_fmac_f32 v8, v148, v148
    v_fmac_f32 v8, v149, v149
    v_fmac_f32 v8, v150, v150
    v_fmac_f32 v8, v151, v151
    s_nop 1
    v_add_f32_dpp v8, v8, v8 quad_perm:[1,0,3,2] row_mask:0xf bank_mask:0xf
    s_nop 1
    v_add_f32_dpp v8, v8, v8 quad_perm:[2,3,0,1] row_mask:0xf bank_mask:0xf
    s_nop 1
    v_add_f32_dpp v8, v8, v8 row_half_mirror row_mask:0xf bank_mask:0xf
    s_nop 1
    v_add_f32_dpp v8, v8, v8 row_mirror row_mask:0xf bank_mask:0xf
    v_mov_b32 v7, v8
    s_nop 1
    v_permlane16_swap_b32 v8, v7
    s_nop 0
    v_add_f32 v8, v8, v7
    v_mov_b32 v7, v8
    s_nop 1
    v_permlane32_swap_b32 v8, v7
    s_nop 0
    v_add_f32 v8, v8, v7
    v_mul_f32 v8, 0x3b000000, v8
    v_cvt_pk_bf16_f32 v6, v6, v6
    v_lshlrev_b32 v6, 16, v6
    v_cvt_pk_bf16_f32 v8, v8, v8
    v_lshlrev_b32 v8, 16, v8
    v_add_f32 v8, 0x3727c5ac, v8
    v_cvt_pk_bf16_f32 v8, v8, v8
    v_lshlrev_b32 v8, 16, v8
    v_sqrt_f32 v8, v8
    s_nop 0
    v_cvt_pk_bf16_f32 v8, v8, v8
    v_lshlrev_b32 v8, 16, v8
    v_rcp_f32 v8, v8
    v_sub_f32 v136, v136, v6
    v_sub_f32 v137, v137, v6
    v_sub_f32 v138, v138, v6
    v_sub_f32 v139, v139, v6
    v_sub_f32 v140, v140, v6
    v_sub_f32 v141, v141, v6
    v_sub_f32 v142, v142, v6
    v_sub_f32 v143, v143, v6
    v_cvt_pk_bf16_f32 v144, v136, v137
    v_cvt_pk_bf16_f32 v145, v138, v139
    v_cvt_pk_bf16_f32 v146, v140, v141
    v_cvt_pk_bf16_f32 v147, v142, v143
    v_lshlrev_b32 v136, 16, v144
    v_and_b32 v137, 0xffff0000, v144
    v_lshlrev_b32 v138, 16, v145
    v_and_b32 v139, 0xffff0000, v145
    v_lshlrev_b32 v140, 16, v146
    v_and_b32 v141, 0xffff0000, v146
    v_lshlrev_b32 v142, 16, v147
    v_and_b32 v143, 0xffff0000, v147
    v_mul_f32 v136, v136, v8
    v_mul_f32 v137, v137, v8
    v_mul_f32 v138, v138, v8
    v_mul_f32 v139, v139, v8
    v_mul_f32 v140, v140, v8
    v_mul_f32 v141, v141, v8
    v_mul_f32 v142, v142, v8
    v_mul_f32 v143, v143, v8
    v_cvt_pk_bf16_f32 v144, v136, v137
    v_cvt_pk_bf16_f32 v145, v138, v139
    v_cvt_pk_bf16_f32 v146, v140, v141
    v_cvt_pk_bf16_f32 v147, v142, v143
    s_lshl_b32 s60, s33, 10
    v_lshl_add_u32 v6, v1, 4, s60
    ds_write_b128 v6, v[144:147] offset:0
    s_waitcnt lgkmcnt(0)
    s_branch L_svc_fw2
L_svc_fw:
    s_branch L_stub1
L_ret1:
L_svc_fw2:
    s_barrier
    s_add_u32 s60, s57, 0
    s_add_u32 m0, s38, 4096
    s_nop 0
    buffer_load_dwordx4 v10, s[44:47], s60 offen lds
    s_add_u32 s60, s57, 32768
    s_add_u32 m0, s38, 5120
    s_nop 0
    buffer_load_dwordx4 v10, s[44:47], s60 offen lds
    s_add_u32 s60, s57, 65536
    s_add_u32 m0, s38, 6144
    s_nop 0
    buffer_load_dwordx4 v11, s[44:47], s60 offen lds
    s_add_u32 s60, s57, 98304
    s_add_u32 m0, s38, 7168
    s_nop 0
    buffer_load_dwordx4 v11, s[44:47], s60 offen lds
    s_add_u32 s60, s58, 0
    s_add_u32 m0, s38, 8192
    s_nop 0
    buffer_load_dwordx4 v10, s[44:47], s60 offen lds
    s_add_u32 s60, s58, 32768
    s_add_u32 m0, s38, 9216
    s_nop 0
    buffer_load_dwordx4 v10, s[44:47], s60 offen lds
    s_add_u32 s60, s58, 65536
    s_add_u32 m0, s38, 10240
    s_nop 0
    buffer_load_dwordx4 v11, s[44:47], s60 offen lds
    s_add_u32 s60, s58, 98304
    s_add_u32 m0, s38, 11264
    s_nop 0
    buffer_load_dwordx4 v11, s[44:47], s60 offen lds
    s_add_u32 s60, s59, 0
    s_add_u32 m0, s38, 12288
    s_nop 0
    buffer_load_dwordx4 v10, s[44:47], s60 offen lds
    s_add_u32 s60, s59, 32768
    s_add_u32 m0, s38, 13312
    s_nop 0
    buffer_load_dwordx4 v10, s[44:47], s60 offen lds
    s_add_u32 s60, s59, 65536
    s_add_u32 m0, s38, 14336
    s_nop 0
    buffer_load_dwordx4 v11, s[44:47], s60 offen lds
    s_add_u32 s60, s59, 98304
    s_add_u32 m0, s38, 15360
    s_nop 0
    buffer_load_dwordx4 v11, s[44:47], s60 offen lds
    s_mov_b32 s39, s3
    s_lshl_b32 s58, s34, 12
    s_add_u32 s58, s58, 1048576
    v_lshrrev_b32 v4, 2, v3
    v_and_b32 v5, 3, v3
    v_and_b32 v7, 1, v2
    v_lshlrev_b32 v7, 3, v7
    v_lshl_or_b32 v14, v4, 1, v7
    v_lshrrev_b32 v6, 1, v5
    v_xor_b32 v13, v6, v14
    v_lshlrev_b32 v13, 4, v13
    v_and_b32 v6, 1, v5
    v_lshl_or_b32 v13, v6, 3, v13
    v_lshl_add_u32 v6, v2, 3, v4
    v_lshl_add_u32 v6, v6, 8, v13
    v_add_u32 v20, s38, v6
    v_xor_b32 v21, 32, v20
    v_xor_b32 v22, 64, v20
    v_xor_b32 v23, 96, v20
    v_xor_b32 v24, 128, v20
    v_xor_b32 v25, 160, v20
    v_xor_b32 v26, 192, v20
    v_xor_b32 v27, 224, v20
    v_and_b32 v16, 1, v3
    v_lshlrev_b32 v6, 4, v2
    v_lshl_add_u32 v17, v16, 8, v6
    v_lshl_add_u32 v16, v16, 10, v6
    s_lshl_b32 s60, s33, 7
    v_add_u32 v16, s60, v16
    v_lshrrev_b32 v7, 1, v2
    v_add_u32 v7, s36, v7
    v_and_b32 v7, 3, v7
    v_lshlrev_b32 v7, 5, v7
    v_and_b32 v28, 0xffffffdf, v16
    v_add_u32 v28, v28, v7
    v_xor_b32 v29, 64, v28
    s_movk_i32 s60, 272
    v_mad_u32_u24 v18, v3, s60, v6
    v_lshlrev_b32 v6, 3, v2
    v_mad_u32_u24 v19, v3, s60, v6
    s_mul_i32 s60, s33, 544
    v_add_u32 v19, s60, v19
    v_lshl_add_u32 v30, v3, 8, v6
    s_lshl_b32 s60, s33, 5
    v_add_u32 v30, s60, v30
    s_waitcnt lgkmcnt(0)
    s_add_u32 s32, s32, 1
    s_and_b32 s3, s32, 0xff
    s_bfe_u32 s52, s32, 0x10000
    s_bfe_u32 s60, s32, 0x10001
    s_lshl_b32 s60, s60, 16
    s_or_b32 s52, s52, s60
    s_bfe_u32 s53, s32, 0x10002
    s_bfe_u32 s60, s32, 0x10003
    s_lshl_b32 s60, s60, 16
    s_or_b32 s53, s53, s60
    s_bfe_u32 s54, s32, 0x10004
    s_bfe_u32 s60, s32, 0x10005
    s_lshl_b32 s60, s60, 16
    s_or_b32 s54, s54, s60
    s_bfe_u32 s55, s32, 0x10006
    s_bfe_u32 s60, s32, 0x10007
    s_lshl_b32 s60, s60, 16
    s_or_b32 s55, s55, s60
    ds_read_b128 v[240:243], v28 offset:0
    ds_read_b128 v[244:247], v29 offset:0
    s_waitcnt vmcnt(8)
    ds_read_b64_tr_b16 v[128:129], v20 offset:0
    ds_read_b64_tr_b16 v[130:131], v20 offset:1024
    ds_read_b64_tr_b16 v[132:133], v21 offset:0
    ds_read_b64_tr_b16 v[134:135], v21 offset:1024
    ds_read_b64_tr_b16 v[136:137], v22 offset:0
    ds_read_b64_tr_b16 v[138:139], v22 offset:1024
    ds_read_b64_tr_b16 v[140:141], v23 offset:0
    ds_read_b64_tr_b16 v[142:143], v23 offset:1024
    ds_read_b64_tr_b16 v[144:145], v24 offset:0
    ds_read_b64_tr_b16 v[146:147], v24 offset:1024
    ds_read_b64_tr_b16 v[148:149], v25 offset:0
    ds_read_b64_tr_b16 v[150:151], v25 offset:1024
    s_waitcnt lgkmcnt(8)
    ds_read_b64_tr_b16 v[152:153], v26 offset:0
    ds_read_b64_tr_b16 v[154:155], v26 offset:1024
    ds_read_b64_tr_b16 v[156:157], v27 offset:0
    ds_read_b64_tr_b16 v[158:159], v27 offset:1024
    v_mfma_f32_16x16x32_bf16 v[192:195], v[128:131], v[240:243], 0
    v_mfma_f32_16x16x32_bf16 v[196:199], v[132:135], v[240:243], 0
    s_waitcnt lgkmcnt(10)
    v_mfma_f32_16x16x32_bf16 v[200:203], v[136:139], v[240:243], 0
    s_waitcnt lgkmcnt(8)
    v_mfma_f32_16x16x32_bf16 v[204:207], v[140:143], v[240:243], 0
    s_waitcnt lgkmcnt(6)
    v_mfma_f32_16x16x32_bf16 v[208:211], v[144:147], v[240:243], 0
    s_waitcnt lgkmcnt(4)
    v_mfma_f32_16x16x32_bf16 v[212:215], v[148:151], v[240:243], 0
    s_waitcnt lgkmcnt(2)
    v_mfma_f32_16x16x32_bf16 v[216:219], v[152:155], v[240:243], 0
    s_waitcnt lgkmcnt(0)
    v_mfma_f32_16x16x32_bf16 v[220:223], v[156:159], v[240:243], 0
    buffer_load_dwordx4 v[32:35], v12, s[48:51], s37 offen offset:0
    buffer_load_dwordx4 v[36:39], v12, s[48:51], s37 offen offset:64
    buffer_load_dwordx4 v[40:43], v12, s[48:51], s37 offen offset:128
    buffer_load_dwordx4 v[44:47], v12, s[48:51], s37 offen offset:192
    s_waitcnt vmcnt(4)
    ds_read_b64_tr_b16 v[160:161], v20 offset:8192
    ds_read_b64_tr_b16 v[162:163], v20 offset:9216
    ds_read_b64_tr_b16 v[164:165], v21 offset:8192
    ds_read_b64_tr_b16 v[166:167], v21 offset:9216
    ds_read_b64_tr_b16 v[168:169], v22 offset:8192
    ds_read_b64_tr_b16 v[170:171], v22 offset:9216
    ds_read_b64_tr_b16 v[172:173], v23 offset:8192
    ds_read_b64_tr_b16 v[174:175], v23 offset:9216
    ds_read_b64_tr_b16 v[176:177], v24 offset:8192
    ds_read_b64_tr_b16 v[178:179], v24 offset:9216
    ds_read_b64_tr_b16 v[180:181], v25 offset:8192
    ds_read_b64_tr_b16 v[182:183], v25 offset:9216
    s_waitcnt lgkmcnt(8)
    ds_read_b64_tr_b16 v[184:185], v26 offset:8192
    ds_read_b64_tr_b16 v[186:187], v26 offset:9216
    ds_read_b64_tr_b16 v[188:189], v27 offset:8192
    ds_read_b64_tr_b16 v[190:191], v27 offset:9216
    v_mfma_f32_16x16x32_bf16 v[192:195], v[160:163], v[244:247], v[192:195]
    v_mfma_f32_16x16x32_bf16 v[196:199], v[164:167], v[244:247], v[196:199]
    s_waitcnt lgkmcnt(10)
    v_mfma_f32_16x16x32_bf16 v[200:203], v[168:171], v[244:247], v[200:203]
    s_waitcnt lgkmcnt(8)
    v_mfma_f32_16x16x32_bf16 v[204:207], v[172:175], v[244:247], v[204:207]
    s_waitcnt lgkmcnt(6)
    v_mfma_f32_16x16x32_bf16 v[208:211], v[176:179], v[244:247], v[208:211]
    s_waitcnt lgkmcnt(4)
    v_mfma_f32_16x16x32_bf16 v[212:215], v[180:183], v[244:247], v[212:215]
    s_waitcnt lgkmcnt(2)
    v_mfma_f32_16x16x32_bf16 v[216:219], v[184:187], v[244:247], v[216:219]
    s_waitcnt lgkmcnt(0)
    v_mfma_f32_16x16x32_bf16 v[220:223], v[188:191], v[244:247], v[220:223]
    s_mov_b32 exec_lo, 0x00030003
    s_mov_b32 exec_hi, 0x00030003
    v_cvt_pk_bf16_f32 v192, v192, v193
    v_cvt_pk_bf16_f32 v193, v194, v195
    ds_write_b64 v19, v[192:193] offset:2048
    v_cvt_pk_bf16_f32 v196, v196, v197
    v_cvt_pk_bf16_f32 v197, v198, v199
    ds_write_b64 v19, v[196:197] offset:2080
    v_cvt_pk_bf16_f32 v200, v200, v201
    v_cvt_pk_bf16_f32 v201, v202, v203
    ds_write_b64 v19, v[200:201] offset:2112
    v_cvt_pk_bf16_f32 v204, v204, v205
    v_cvt_pk_bf16_f32 v205, v206, v207
    ds_write_b64 v19, v[204:205] offset:2144
    v_cvt_pk_bf16_f32 v208, v208, v209
    v_cvt_pk_bf16_f32 v209, v210, v211
    ds_write_b64 v19, v[208:209] offset:2176
    v_cvt_pk_bf16_f32 v212, v212, v213
    v_cvt_pk_bf16_f32 v213, v214, v215
    ds_write_b64 v19, v[212:213] offset:2208
    s_nop 0
    v_cvt_pk_bf16_f32 v216, v216, v217
    v_cvt_pk_bf16_f32 v217, v218, v219
    ds_write_b64 v19, v[216:217] offset:2240
    v_cvt_pk_bf16_f32 v220, v220, v221
    v_cvt_pk_bf16_f32 v221, v222, v223
    ds_write_b64 v19, v[220:221] offset:2272
    s_mov_b64 exec, -1
    s_mov_b32 s63, 0x3e0293ee
    s_waitcnt vmcnt(0) lgkmcnt(0)
    s_barrier
    ds_read_b128 v[128:131], v18 offset:2048
    ds_read_b128 v[132:135], v18 offset:2112
    ds_read_b128 v[136:139], v18 offset:2176
    ds_read_b128 v[140:143], v18 offset:2240
    s_waitcnt lgkmcnt(3)
    v_mfma_f32_16x16x32_bf16 v[192:195], v[32:35], v[128:131], 0
    s_waitcnt lgkmcnt(2)
    v_mfma_f32_16x16x32_bf16 v[192:195], v[36:39], v[132:135], v[192:195]
    s_waitcnt lgkmcnt(1)
    v_mfma_f32_16x16x32_bf16 v[192:195], v[40:43], v[136:139], v[192:195]
    s_waitcnt lgkmcnt(0)
    v_mfma_f32_16x16x32_bf16 v[192:195], v[44:47], v[140:143], v[192:195]
    s_nop 7
    v_add_f32_dpp v192, v192, v192 quad_perm:[2,3,0,1] row_mask:0xf bank_mask:0xf
    v_add_f32_dpp v193, v193, v193 quad_perm:[2,3,0,1] row_mask:0xf bank_mask:0xf
    v_add_f32_dpp v194, v194, v194 quad_perm:[2,3,0,1] row_mask:0xf bank_mask:0xf
    v_add_f32_dpp v195, v195, v195 quad_perm:[2,3,0,1] row_mask:0xf bank_mask:0xf
    v_add_f32_dpp v192, v192, v192 row_ror:4 row_mask:0xf bank_mask:0xf
    v_add_f32_dpp v193, v193, v193 row_ror:4 row_mask:0xf bank_mask:0xf
    v_add_f32_dpp v194, v194, v194 row_ror:4 row_mask:0xf bank_mask:0xf
    v_add_f32_dpp v195, v195, v195 row_ror:4 row_mask:0xf bank_mask:0xf
    v_add_f32_dpp v192, v192, v192 row_ror:8 row_mask:0xf bank_mask:0xf
    v_add_f32_dpp v193, v193, v193 row_ror:8 row_mask:0xf bank_mask:0xf
    v_add_f32_dpp v194, v194, v194 row_ror:8 row_mask:0xf bank_mask:0xf
    v_add_f32_dpp v195, v195, v195 row_ror:8 row_mask:0xf bank_mask:0xf
    v_mul_f32 v192, s63, v192
    v_mul_f32 v193, s63, v193
    v_mul_f32 v194, s63, v194
    v_mul_f32 v195, s63, v195
    v_add_u32 v192, 0x10000, v192
    v_add_u32 v193, 0x10000, v193
    v_add_u32 v194, 0x10000, v194
    v_add_u32 v195, 0x10000, v195
    s_mov_b32 s63, 0x07060302
    v_perm_b32 v192, v193, v192, s63
    v_perm_b32 v193, v195, v194, s63
    s_mov_b32 exec_lo, 0x00030003
    s_mov_b32 exec_hi, 0x00030003
    ds_write_b64 v30, v[192:193] offset:6400
    s_mov_b64 exec, -1
    v_mov_b32 v6, s32
    v_mov_b32 v7, 0
    v_lshlrev_b32 v8, 4, v1
    s_lshl_b32 s60, s34, 7
    s_add_u32 s60, s60, 262144
    s_waitcnt lgkmcnt(0)
    s_barrier
    s_cmp_lg_u32 s33, 0
    s_cbranch_scc1 L_svc_nohint
    s_mov_b32 exec_hi, 0
    ds_read_b128 v[192:195], v8 offset:6400
    v_mov_b32 v196, 0xfffefffe
    s_waitcnt lgkmcnt(0)
    v_bfi_b32 v192, v196, v192, s52
    v_bfi_b32 v193, v196, v193, s53
    v_bfi_b32 v194, v196, v194, s54
    v_bfi_b32 v195, v196, v195, s55
    buffer_store_dwordx4 v[192:195], v9, s[40:43], s39 offen sc1
    s_mov_b64 exec, 1
    buffer_store_dword v6, v7, s[40:43], s60 offen sc1
    s_mov_b64 exec, -1
L_svc_nohint:
    s_waitcnt vmcnt(0)
    s_barrier
    s_mov_b32 s44, s6
    s_mov_b32 s45, s7
    s_mov_b32 s46, 0x2000000
    s_mov_b32 s47, 0x20000
    s_lshl_b32 s60, s34, 18
    s_lshl_b32 s63, s33, 12
    s_add_u32 s60, s60, s63
    s_add_u32 s60, s60, 163840
    v_lshlrev_b32 v6, 7, v1
    s_mov_b32 exec_hi, 0
    buffer_load_dword v255, v6, s[44:47], s60 offen
    s_add_u32 s60, s60, 32768
    buffer_load_dword v255, v6, s[44:47], s60 offen
    s_add_u32 s60, s60, 32768
    buffer_load_dword v255, v6, s[44:47], s60 offen
    s_add_u32 s60, s60, 32768
    s_mov_b64 exec, -1
    s_waitcnt vmcnt(0)
    s_branch L_pg1
.p2align 12
L_stub1:
    s_branch L_ret1
L_pg1:
    s_mov_b32 s44, s12
    s_mov_b32 s45, s13
    s_mov_b32 s46, 0x400000
    s_mov_b32 s47, 0x20000
    s_mov_b32 s48, s14
    s_mov_b32 s49, s15
    s_mov_b32 s50, 0x400000
    s_mov_b32 s51, 0x20000
    v_lshrrev_b32 v6, 3, v1
    v_and_b32 v7, 7, v1
    v_bfe_u32 v8, v1, 4, 1
    v_lshlrev_b32 v8, 1, v8
    v_xor_b32 v7, v7, v8
    v_lshlrev_b32 v7, 4, v7
    v_lshl_add_u32 v18, v6, 10, v7
    v_xor_b32 v19, 64, v18
    s_lshl_b32 s39, s35, 17
    s_lshl_b32 s60, s33, 7
    s_add_u32 s39, s39, s60
    v_and_b32 v6, 2, v4
    v_and_b32 v7, 1, v2
    v_lshl_or_b32 v6, v7, 2, v6
    v_lshrrev_b32 v7, 1, v5
    v_xor_b32 v6, v6, v7
    v_lshlrev_b32 v6, 4, v6
    v_and_b32 v7, 1, v5
    v_lshl_or_b32 v6, v7, 3, v6
    v_lshl_add_u32 v7, v2, 3, v4
    v_lshl_add_u32 v6, v7, 7, v6
    v_add_u32 v20, s38, v6
    v_xor_b32 v21, 32, v20
    v_xor_b32 v22, 64, v20
    v_xor_b32 v23, 96, v20
    v_lshrrev_b32 v6, 1, v2
    v_lshlrev_b32 v6, 14, v6
    v_and_b32 v7, 1, v2
    v_lshl_add_u32 v7, v7, 2, v4
    v_lshl_add_u32 v6, v7, 8, v6
    s_lshl_b32 s60, s33, 5
    v_xor_b32 v15, s60, v13
    v_add_u32 v15, v15, v6
    v_add_u32 v14, 0x10000, v15
    v_lshlrev_b32 v6, 4, v2
    v_lshl_add_u32 v24, v3, 11, v6
    s_lshl_b32 s60, s33, 8
    v_add_u32 v24, s60, v24
    v_mov_b32 v9, 0xffffff00
    s_xor_b32 s60, s36, 0
    s_lshl_b32 s60, s60, 15
    s_add_u32 s8, s39, s60
    s_xor_b32 s60, s36, 1
    s_lshl_b32 s60, s60, 15
    s_add_u32 s9, s39, s60
    s_xor_b32 s60, s36, 2
    s_lshl_b32 s60, s60, 15
    s_add_u32 s10, s39, s60
    s_xor_b32 s60, s36, 3
    s_lshl_b32 s60, s60, 15
    s_add_u32 s11, s39, s60
    s_lshl_b32 s60, s36, 6
    v_or_b32 v17, s60, v17
    s_add_u32 s60, s37, 0
    s_add_u32 m0, s38, 0
    s_nop 0
    buffer_load_dwordx4 v10, s[44:47], s60 offen lds
    s_add_u32 s60, s37, 32768
    s_add_u32 m0, s38, 1024
    s_nop 0
    buffer_load_dwordx4 v11, s[44:47], s60 offen lds
    s_add_u32 s60, s37, 65536
    s_add_u32 m0, s38, 2048
    s_nop 0
    buffer_load_dwordx4 v10, s[44:47], s60 offen lds
    s_add_u32 s60, s37, 98304
    s_add_u32 m0, s38, 3072
    s_nop 0
    buffer_load_dwordx4 v11, s[44:47], s60 offen lds
    s_add_u32 s60, s8, 0
    s_add_u32 m0, s38, 4096
    s_nop 0
    buffer_load_dwordx4 v18, s[48:51], s60 offen lds
    s_add_u32 s60, s8, 8192
    s_add_u32 m0, s38, 5120
    s_nop 0
    buffer_load_dwordx4 v19, s[48:51], s60 offen lds
    s_add_u32 s60, s8, 16384
    s_add_u32 m0, s38, 6144
    s_nop 0
    buffer_load_dwordx4 v18, s[48:51], s60 offen lds
    s_add_u32 s60, s8, 24576
    s_add_u32 m0, s38, 7168
    s_nop 0
    buffer_load_dwordx4 v19, s[48:51], s60 offen lds
    s_add_u32 s60, s9, 0
    s_add_u32 m0, s38, 8192
    s_nop 0
    buffer_load_dwordx4 v18, s[48:51], s60 offen lds
    s_add_u32 s60, s9, 8192
    s_add_u32 m0, s38, 9216
    s_nop 0
    buffer_load_dwordx4 v19, s[48:51], s60 offen lds
    s_add_u32 s60, s9, 16384
    s_add_u32 m0, s38, 10240
    s_nop 0
    buffer_load_dwordx4 v18, s[48:51], s60 offen lds
    s_add_u32 s60, s9, 24576
    s_add_u32 m0, s38, 11264
    s_nop 0
    buffer_load_dwordx4 v19, s[48:51], s60 offen lds
    s_add_u32 s60, s10, 0
    s_add_u32 m0, s38, 12288
    s_nop 0
    buffer_load_dwordx4 v18, s[48:51], s60 offen lds
    s_add_u32 s60, s10, 8192
    s_add_u32 m0, s38, 13312
    s_nop 0
    buffer_load_dwordx4 v19, s[48:51], s60 offen lds
    s_add_u32 s60, s10, 16384
    s_add_u32 m0, s38, 14336
    s_nop 0
    buffer_load_dwordx4 v18, s[48:51], s60 offen lds
    s_add_u32 s60, s10, 24576
    s_add_u32 m0, s38, 15360
    s_nop 0
    buffer_load_dwordx4 v19, s[48:51], s60 offen lds
    s_waitcnt vmcnt(15)
    s_waitcnt vmcnt(8)
    ds_read_b64_tr_b16 v[64:65], v20 offset:4096
    ds_read_b64_tr_b16 v[66:67], v20 offset:4608
    ds_read_b64_tr_b16 v[68:69], v21 offset:4096
    ds_read_b64_tr_b16 v[70:71], v21 offset:4608
    ds_read_b64_tr_b16 v[72:73], v22 offset:4096
    ds_read_b64_tr_b16 v[74:75], v22 offset:4608
    ds_read_b64_tr_b16 v[76:77], v23 offset:4096
    ds_read_b64_tr_b16 v[78:79], v23 offset:4608
    s_waitcnt lgkmcnt(0)
    s_add_u32 s60, s11, 0
    s_add_u32 m0, s38, 4096
    s_nop 0
    buffer_load_dwordx4 v18, s[48:51], s60 offen lds
    s_add_u32 s60, s11, 8192
    s_add_u32 m0, s38, 5120
    s_nop 0
    buffer_load_dwordx4 v19, s[48:51], s60 offen lds
    s_add_u32 s60, s11, 16384
    s_add_u32 m0, s38, 6144
    s_nop 0
    buffer_load_dwordx4 v18, s[48:51], s60 offen lds
    s_add_u32 s60, s11, 24576
    s_add_u32 m0, s38, 7168
    s_nop 0
    buffer_load_dwordx4 v19, s[48:51], s60 offen lds
    s_barrier
    ds_read_b64_tr_b16 v[48:49], v15 offset:16384
    ds_read_b64_tr_b16 v[50:51], v15 offset:18432
    ds_read_b64_tr_b16 v[52:53], v15 offset:49152
    ds_read_b64_tr_b16 v[54:55], v15 offset:51200
    ds_read_b64_tr_b16 v[56:57], v14 offset:16384
    ds_read_b64_tr_b16 v[58:59], v14 offset:18432
    ds_read_b64_tr_b16 v[60:61], v14 offset:49152
    ds_read_b64_tr_b16 v[62:63], v14 offset:51200
    s_waitcnt vmcnt(8)
    ds_read_b64_tr_b16 v[80:81], v20 offset:8192
    ds_read_b64_tr_b16 v[82:83], v20 offset:8704
    ds_read_b64_tr_b16 v[84:85], v21 offset:8192
    ds_read_b64_tr_b16 v[86:87], v21 offset:8704
    ds_read_b64_tr_b16 v[88:89], v22 offset:8192
    ds_read_b64_tr_b16 v[90:91], v22 offset:8704
    ds_read_b64_tr_b16 v[92:93], v23 offset:8192
    s_waitcnt lgkmcnt(14)
    ds_read_b64_tr_b16 v[94:95], v23 offset:8704
    s_waitcnt vmcnt(4)
    s_waitcnt lgkmcnt(14)
    ds_read_b64_tr_b16 v[96:97], v20 offset:12288
    s_waitcnt lgkmcnt(14)
    ds_read_b64_tr_b16 v[98:99], v20 offset:12800
    s_waitcnt lgkmcnt(14)
    ds_read_b64_tr_b16 v[100:101], v21 offset:12288
    s_waitcnt lgkmcnt(14)
    ds_read_b64_tr_b16 v[102:103], v21 offset:12800
    s_waitcnt lgkmcnt(14)
    ds_read_b64_tr_b16 v[104:105], v22 offset:12288
    s_waitcnt lgkmcnt(14)
    ds_read_b64_tr_b16 v[106:107], v22 offset:12800
    s_waitcnt lgkmcnt(14)
    ds_read_b64_tr_b16 v[108:109], v23 offset:12288
    s_waitcnt lgkmcnt(14)
    ds_read_b64_tr_b16 v[110:111], v23 offset:12800
    s_waitcnt vmcnt(0)
    s_waitcnt lgkmcnt(14)
    ds_read_b64_tr_b16 v[112:113], v20 offset:4096
    s_waitcnt lgkmcnt(14)
    ds_read_b64_tr_b16 v[114:115], v20 offset:4608
    s_waitcnt lgkmcnt(14)
    ds_read_b64_tr_b16 v[116:117], v21 offset:4096
    s_waitcnt lgkmcnt(14)
    ds_read_b64_tr_b16 v[118:119], v21 offset:4608
    s_waitcnt lgkmcnt(14)
    ds_read_b64_tr_b16 v[120:121], v22 offset:4096
    s_waitcnt lgkmcnt(14)
    ds_read_b64_tr_b16 v[122:123], v22 offset:4608
    s_waitcnt lgkmcnt(14)
    ds_read_b64_tr_b16 v[124:125], v23 offset:4096
    s_waitcnt lgkmcnt(14)
    ds_read_b64_tr_b16 v[126:127], v23 offset:4608
L_svc_combine:
    s_lshl_b32 s60, s35, 2
    s_add_u32 s60, s60, s36
    s_lshl_b32 s63, s33, 13
    s_lshl_b32 s39, s35, 4
    s_add_u32 s63, s63, s39
    s_add_u32 s63, s63, 524288
    s_lshl_b32 s39, s60, 15
    s_lshl_b32 s60, s33, 12
    s_add_u32 s39, s39, s60
    s_add_u32 s39, s39, 2097152
    v_lshlrev_b32 v25, 4, v1
    s_mul_i32 s60, s33, 272
    v_lshlrev_b32 v6, 4, v3
    v_lshl_add_u32 v27, v2, 2, v6
    v_add_u32 v27, s60, v27
    v_and_b32 v6, 7, v3
    s_movk_i32 s60, 272
    v_lshlrev_b32 v7, 4, v2
    v_mad_u32_u24 v28, v6, s60, v7
    v_lshlrev_b32 v29, 3, v6
    v_lshrrev_b32 v6, 2, v3
    v_lshlrev_b32 v6, 8, v6
    v_lshl_add_u32 v6, v2, 3, v6
    s_lshl_b32 s60, s33, 5
    v_add_u32 v30, s60, v6
    s_lshl_b32 s60, s33, 3
    v_mov_b32 v31, s60
    v_xor_b32 v20, 0, v17
    v_xor_b32 v21, 64, v17
    v_xor_b32 v22, 128, v17
    v_xor_b32 v23, 192, v17
    v_mov_b32 v12, 0x8000
    v_mov_b32 v13, 0xffff0000
    v_mov_b32 v14, 0x10001
    s_mov_b32 s6, 0xcccccccc
    s_mov_b32 s7, 0xcccccccc
    s_mov_b32 s12, 0xf0f0f0f0
    s_mov_b32 s13, 0xf0f0f0f0
    v_and_b32 v6, 1, v3
    v_lshlrev_b32 v15, 11, v6
    v_lshrrev_b32 v6, 1, v3
    v_lshl_add_u32 v15, v6, 6, v15
    v_lshl_add_u32 v15, v2, 4, v15
    s_lshl_b32 s60, s33, 8
    v_add_u32 v15, s60, v15
    s_waitcnt lgkmcnt(0)
    v_and_b32 v6, 3, v3
    v_lshl_add_u32 v6, v6, 2, v2
    v_lshlrev_b32 v26, 9, v6
    v_lshlrev_b32 v7, 7, v3
    s_lshl_b32 s56, s33, 11
    s_add_u32 s56, s56, 327680
    s_mov_b32 s61, 0
    s_mov_b64 exec, 1
L_m1_1:
    buffer_load_dword v128, v7, s[40:43], s56 offen sc1
    s_waitcnt vmcnt(0)
    v_cmp_ne_u32 vcc, s32, v128
    s_cbranch_vccz L_m1d_2
    s_add_u32 s61, s61, 1
    s_cmp_gt_u32 s61, s62
    s_cbranch_scc1 L_m1d_2
    s_sleep 3
    s_branch L_m1_1
L_m1d_2:
    s_mov_b32 s61, 0
    s_mov_b64 exec, 0xffff
L_ml_3:
    buffer_load_dword v128, v7, s[40:43], s56 offen sc1
    s_waitcnt vmcnt(0)
    v_cmp_eq_u32 vcc, s32, v128
    s_bcnt1_i32_b64 s60, vcc
    s_cmp_ge_u32 s60, 16
    s_cbranch_scc1 L_mld_4
    s_add_u32 s61, s61, 1
    s_cmp_gt_u32 s61, s62
    s_cbranch_scc1 L_mld_4
    s_sleep 3
    s_branch L_ml_3
L_mld_4:
    s_mov_b64 exec, -1
    s_mov_b32 s61, 0
L_og_5:
    buffer_load_dwordx4 v[128:131], v26, s[40:43], s63 offen sc1
    buffer_load_dwordx4 v[144:147], v25, s[40:43], s39 offen offset:0 sc1
    buffer_load_dwordx4 v[148:151], v25, s[40:43], s39 offen offset:1024 sc1
    buffer_load_dwordx4 v[152:155], v25, s[40:43], s39 offen offset:2048 sc1
    buffer_load_dwordx4 v[156:159], v25, s[40:43], s39 offen offset:3072 sc1
    s_waitcnt vmcnt(4)
    v_max_f32_dpp v132, v128, v128 quad_perm:[1,0,3,2] row_mask:0xf bank_mask:0xf
    v_xor_b32 v129, s32, v129
    v_xor_b32 v131, s32, v131
    v_max_f32_dpp v132, v132, v132 quad_perm:[2,3,0,1] row_mask:0xf bank_mask:0xf
    v_or_b32 v7, v129, v131
    v_mov_b32 v133, v132
    s_nop 1
    v_permlane16_swap_b32 v132, v133
    s_nop 0
    v_max_f32 v132, v132, v133
    v_mov_b32 v133, v132
    s_nop 1
    v_permlane32_swap_b32 v132, v133
    s_nop 0
    v_max_f32 v132, v132, v133
    v_sub_f32 v128, v128, v132
    v_exp_f32 v128, v128
    v_mov_b32 v129, v132
    v_mul_f32 v130, v130, v128
    v_mov_b32 v6, 0
    v_mov_b32_dpp v132, v128 quad_perm:[0,0,0,0] row_mask:0xf bank_mask:0xf
    v_mov_b32_dpp v134, v128 quad_perm:[1,1,1,1] row_mask:0xf bank_mask:0xf
    v_mov_b32_dpp v136, v128 quad_perm:[2,2,2,2] row_mask:0xf bank_mask:0xf
    v_mov_b32_dpp v138, v128 quad_perm:[3,3,3,3] row_mask:0xf bank_mask:0xf
    s_waitcnt vmcnt(3)
    v_xor_b32 v144, s52, v144
    v_xor_b32 v145, s53, v145
    v_xor_b32 v146, s54, v146
    v_xor_b32 v147, s55, v147
    v_lshl_or_b32 v160, v144, 16, v12
    v_and_or_b32 v161, v144, v13, v12
    v_lshl_or_b32 v162, v145, 16, v12
    v_and_or_b32 v163, v145, v13, v12
    v_lshl_or_b32 v164, v146, 16, v12
    v_and_or_b32 v165, v146, v13, v12
    v_lshl_or_b32 v166, v147, 16, v12
    v_and_or_b32 v167, v147, v13, v12
    v_or3_b32 v6, v6, v144, v145
    v_or3_b32 v6, v6, v146, v147
    v_pk_mul_f32 v[168:169], v[160:161], v[132:133] op_sel_hi:[1,0]
    v_pk_mul_f32 v[170:171], v[162:163], v[132:133] op_sel_hi:[1,0]
    v_pk_mul_f32 v[172:173], v[164:165], v[132:133] op_sel_hi:[1,0]
    v_pk_mul_f32 v[174:175], v[166:167], v[132:133] op_sel_hi:[1,0]
    s_waitcnt vmcnt(2)
    v_xor_b32 v148, s52, v148
    v_xor_b32 v149, s53, v149
    v_xor_b32 v150, s54, v150
    v_xor_b32 v151, s55, v151
    v_lshl_or_b32 v160, v148, 16, v12
    v_and_or_b32 v161, v148, v13, v12
    v_lshl_or_b32 v162, v149, 16, v12
    v_and_or_b32 v163, v149, v13, v12
    v_lshl_or_b32 v164, v150, 16, v12
    v_and_or_b32 v165, v150, v13, v12
    v_lshl_or_b32 v166, v151, 16, v12
    v_and_or_b32 v167, v151, v13, v12
    v_or3_b32 v6, v6, v148, v149
    v_or3_b32 v6, v6, v150, v151
    v_pk_fma_f32 v[168:169], v[160:161], v[134:135], v[168:169] op_sel_hi:[1,0,1]
    v_pk_fma_f32 v[170:171], v[162:163], v[134:135], v[170:171] op_sel_hi:[1,0,1]
    v_pk_fma_f32 v[172:173], v[164:165], v[134:135], v[172:173] op_sel_hi:[1,0,1]
    v_pk_fma_f32 v[174:175], v[166:167], v[134:135], v[174:175] op_sel_hi:[1,0,1]
    s_waitcnt vmcnt(1)
    v_xor_b32 v152, s52, v152
    v_xor_b32 v153, s53, v153
    v_xor_b32 v154, s54, v154
    v_xor_b32 v155, s55, v155
    v_lshl_or_b32 v160, v152, 16, v12
    v_and_or_b32 v161, v152, v13, v12
    v_lshl_or_b32 v162, v153, 16, v12
    v_and_or_b32 v163, v153, v13, v12
    v_lshl_or_b32 v164, v154, 16, v12
    v_and_or_b32 v165, v154, v13, v12
    v_lshl_or_b32 v166, v155, 16, v12
    v_and_or_b32 v167, v155, v13, v12
    v_or3_b32 v6, v6, v152, v153
    v_or3_b32 v6, v6, v154, v155
    v_pk_fma_f32 v[168:169], v[160:161], v[136:137], v[168:169] op_sel_hi:[1,0,1]
    v_pk_fma_f32 v[170:171], v[162:163], v[136:137], v[170:171] op_sel_hi:[1,0,1]
    v_pk_fma_f32 v[172:173], v[164:165], v[136:137], v[172:173] op_sel_hi:[1,0,1]
    v_pk_fma_f32 v[174:175], v[166:167], v[136:137], v[174:175] op_sel_hi:[1,0,1]
    s_waitcnt vmcnt(0)
    v_xor_b32 v156, s52, v156
    v_xor_b32 v157, s53, v157
    v_xor_b32 v158, s54, v158
    v_xor_b32 v159, s55, v159
    v_lshl_or_b32 v160, v156, 16, v12
    v_and_or_b32 v161, v156, v13, v12
    v_lshl_or_b32 v162, v157, 16, v12
    v_and_or_b32 v163, v157, v13, v12
    v_lshl_or_b32 v164, v158, 16, v12
    v_and_or_b32 v165, v158, v13, v12
    v_lshl_or_b32 v166, v159, 16, v12
    v_and_or_b32 v167, v159, v13, v12
    v_or3_b32 v6, v6, v156, v157
    v_or3_b32 v6, v6, v158, v159
    v_and_or_b32 v6, v6, v14, v7
    v_cmp_ne_u32 vcc, 0, v6
    v_pk_fma_f32 v[168:169], v[160:161], v[138:139], v[168:169] op_sel_hi:[1,0,1]
    v_pk_fma_f32 v[170:171], v[162:163], v[138:139], v[170:171] op_sel_hi:[1,0,1]
    v_pk_fma_f32 v[172:173], v[164:165], v[138:139], v[172:173] op_sel_hi:[1,0,1]
    v_pk_fma_f32 v[174:175], v[166:167], v[138:139], v[174:175] op_sel_hi:[1,0,1]
    s_cbranch_vccz L_ogd_6
    s_add_u32 s61, s61, 1
    s_cmp_gt_u32 s61, s62
    s_cbranch_scc1 L_ogd_6
    s_branch L_og_5
L_ogd_6:
    v_add_f32_dpp v130, v130, v130 quad_perm:[1,0,3,2] row_mask:0xf bank_mask:0xf
    s_nop 0
    v_permlane32_swap_b32 v168, v172
    v_permlane32_swap_b32 v169, v173
    v_permlane32_swap_b32 v170, v174
    v_permlane32_swap_b32 v171, v175
    v_add_f32_dpp v130, v130, v130 quad_perm:[2,3,0,1] row_mask:0xf bank_mask:0xf
    v_add_f32 v168, v168, v172
    v_add_f32 v169, v169, v173
    v_add_f32 v170, v170, v174
    v_add_f32 v171, v171, v175
    v_mov_b32 v131, v130
    v_permlane16_swap_b32 v168, v170
    v_permlane16_swap_b32 v169, v171
    v_permlane16_swap_b32 v130, v131
    v_add_f32 v168, v168, v170
    v_add_f32 v169, v169, v171
    v_add_f32 v130, v130, v131
    v_cvt_pk_bf16_f32 v168, v168, v169
    v_mov_b32 v131, v130
    ds_write_b32 v27, v168 offset:6912
    s_nop 0
    v_permlane32_swap_b32 v130, v131
    v_mov_b32 v128, v129
    v_add_f32 v129, v130, v131
    ds_write_b64 v31, v[128:129] offset:9088
    s_waitcnt lgkmcnt(0)
    s_barrier
    ds_read_b64 v[128:129], v29 offset:9088
    ds_read_b128 v[144:147], v28 offset:6912
    ds_read_b128 v[148:151], v28 offset:6976
    ds_read_b128 v[152:155], v28 offset:7040
    ds_read_b128 v[156:159], v28 offset:7104
    s_waitcnt lgkmcnt(4)
    v_max_f32_dpp v130, v128, v128 quad_perm:[1,0,3,2] row_mask:0xf bank_mask:0xf
    s_waitcnt lgkmcnt(3)
    v_mfma_f32_16x16x32_bf16 v[160:163], v[48:51], v[144:147], 0
    s_waitcnt lgkmcnt(2)
    v_mfma_f32_16x16x32_bf16 v[160:163], v[52:55], v[148:151], v[160:163]
    s_waitcnt lgkmcnt(1)
    v_mfma_f32_16x16x32_bf16 v[160:163], v[56:59], v[152:155], v[160:163]
    s_waitcnt lgkmcnt(0)
    v_mfma_f32_16x16x32_bf16 v[160:163], v[60:63], v[156:159], v[160:163]
    v_max_f32_dpp v130, v130, v130 quad_perm:[2,3,0,1] row_mask:0xf bank_mask:0xf
    v_sub_f32 v128, v128, v130
    v_exp_f32 v128, v128
    s_nop 0
    v_mul_f32 v129, v129, v128
    s_nop 1
    v_add_f32_dpp v129, v129, v129 quad_perm:[1,0,3,2] row_mask:0xf bank_mask:0xf
    v_mul_f32 v160, v160, v128
    v_mul_f32 v161, v161, v128
    v_mul_f32 v162, v162, v128
    v_mul_f32 v163, v163, v128
    v_add_f32_dpp v129, v129, v129 quad_perm:[2,3,0,1] row_mask:0xf bank_mask:0xf
    v_add_f32_dpp v160, v160, v160 quad_perm:[1,0,3,2] row_mask:0xf bank_mask:0xf
    v_add_f32_dpp v161, v161, v161 quad_perm:[1,0,3,2] row_mask:0xf bank_mask:0xf
    v_add_f32_dpp v162, v162, v162 quad_perm:[1,0,3,2] row_mask:0xf bank_mask:0xf
    v_add_f32_dpp v163, v163, v163 quad_perm:[1,0,3,2] row_mask:0xf bank_mask:0xf
    v_rcp_f32 v129, v129
    v_add_f32_dpp v160, v160, v160 quad_perm:[2,3,0,1] row_mask:0xf bank_mask:0xf
    v_add_f32_dpp v161, v161, v161 quad_perm:[2,3,0,1] row_mask:0xf bank_mask:0xf
    v_add_f32_dpp v162, v162, v162 quad_perm:[2,3,0,1] row_mask:0xf bank_mask:0xf
    v_add_f32_dpp v163, v163, v163 quad_perm:[2,3,0,1] row_mask:0xf bank_mask:0xf
    v_pk_mul_f32 v[160:161], v[160:161], v[128:129] op_sel:[0,1] op_sel_hi:[1,1]
    v_pk_mul_f32 v[162:163], v[162:163], v[128:129] op_sel:[0,1] op_sel_hi:[1,1]
    v_cvt_pk_bf16_f32 v160, v160, v161
    v_cvt_pk_bf16_f32 v161, v162, v163
    s_mov_b32 exec_lo, 0x00110011
    s_mov_b32 exec_hi, 0x00110011
    ds_write_b64 v30, v[160:161] offset:6400
    s_mov_b64 exec, -1
    s_waitcnt lgkmcnt(0)
    s_barrier
    ds_read_b128 v[144:147], v20 offset:6400
    ds_read_b128 v[148:151], v21 offset:6400
    ds_read_b128 v[152:155], v22 offset:6400
    ds_read_b128 v[156:159], v23 offset:6400
    s_cmp_lg_u32 s33, 0
    s_cbranch_scc1 L_svc_noann
    v_mov_b32 v254, s32
    v_mov_b32 v255, 0
    s_lshl_b32 s60, s34, 7
    s_add_u32 s60, s60, 344064
    s_mov_b64 exec, 1
    buffer_store_dword v254, v255, s[40:43], s60 offen sc1
    s_mov_b64 exec, -1
L_svc_noann:
    s_waitcnt lgkmcnt(3)
    v_mfma_f32_16x16x32_bf16 v[160:163], v[64:67], v[144:147], 0
    v_mfma_f32_16x16x32_bf16 v[164:167], v[68:71], v[144:147], 0
    s_waitcnt lgkmcnt(2)
    v_mfma_f32_16x16x32_bf16 v[160:163], v[80:83], v[148:151], v[160:163]
    v_mfma_f32_16x16x32_bf16 v[164:167], v[84:87], v[148:151], v[164:167]
    s_waitcnt lgkmcnt(1)
    v_mfma_f32_16x16x32_bf16 v[160:163], v[96:99], v[152:155], v[160:163]
    v_mfma_f32_16x16x32_bf16 v[164:167], v[100:103], v[152:155], v[164:167]
    s_waitcnt lgkmcnt(0)
    v_mfma_f32_16x16x32_bf16 v[160:163], v[112:115], v[156:159], v[160:163]
    v_mfma_f32_16x16x32_bf16 v[164:167], v[116:119], v[156:159], v[164:167]
    v_mfma_f32_16x16x32_bf16 v[168:171], v[72:75], v[144:147], 0
    v_mfma_f32_16x16x32_bf16 v[172:175], v[76:79], v[144:147], 0
    v_mfma_f32_16x16x32_bf16 v[168:171], v[88:91], v[148:151], v[168:171]
    v_mfma_f32_16x16x32_bf16 v[172:175], v[92:95], v[148:151], v[172:175]
    v_mfma_f32_16x16x32_bf16 v[168:171], v[104:107], v[152:155], v[168:171]
    v_mfma_f32_16x16x32_bf16 v[172:175], v[108:111], v[152:155], v[172:175]
    v_mfma_f32_16x16x32_bf16 v[168:171], v[120:123], v[156:159], v[168:171]
    v_mfma_f32_16x16x32_bf16 v[172:175], v[124:127], v[156:159], v[172:175]
    v_cndmask_b32 v160, v160, v164, s[6:7]
    v_cndmask_b32 v161, v161, v165, s[6:7]
    v_cndmask_b32 v162, v162, v166, s[6:7]
    v_cndmask_b32 v163, v163, v167, s[6:7]
    s_nop 3
    v_cndmask_b32 v168, v168, v172, s[6:7]
    v_cndmask_b32 v169, v169, v173, s[6:7]
    v_cndmask_b32 v170, v170, v174, s[6:7]
    v_cndmask_b32 v171, v171, v175, s[6:7]
    v_cndmask_b32 v160, v160, v168, s[12:13]
    v_cndmask_b32 v161, v161, v169, s[12:13]
    v_cndmask_b32 v162, v162, v170, s[12:13]
    v_cndmask_b32 v163, v163, v171, s[12:13]
    v_bfi_b32 v160, v9, v160, s3
    v_bfi_b32 v161, v9, v161, s3
    v_bfi_b32 v162, v9, v162, s3
    v_bfi_b32 v163, v9, v163, s3
    s_mov_b32 exec_lo, 0x00ff00ff
    s_mov_b32 exec_hi, 0x00ff00ff
    buffer_store_dwordx4 v[160:163], v15, s[40:43], s58 offen sc1
    s_or_b32 s60, s34, s33
    s_cmp_lg_u32 s60, 0
    s_cbranch_scc1 L_done
    s_mov_b64 exec, 1
    v_mov_b32 v6, s32
    v_mov_b32 v7, 0
    buffer_store_dword v6, v7, s[40:43], 0 offen sc1
    s_branch L_done
.p2align 12
L_att:
    s_mov_b32 s44, s6
    s_mov_b32 s45, s7
    s_mov_b32 s46, 0x2000000
    s_mov_b32 s47, 0x20000
    s_lshl_b32 s35, s34, 18
    v_lshlrev_b32 v8, 2, v2
    v_xor_b32 v8, v8, v3
    v_lshlrev_b32 v8, 4, v8
    v_lshl_add_u32 v4, v2, 10, v8
    v_xor_b32 v5, 16, v4
    v_xor_b32 v6, 32, v4
    v_xor_b32 v7, 48, v4
    s_and_b32 s36, s33, 3
    s_lshl_b32 s36, s36, 15
    s_add_u32 s37, s35, s36
    s_add_u32 s60, s37, 0
    s_add_u32 m0, s36, 0
    s_nop 0
    buffer_load_dwordx4 v4, s[44:47], s60 offen nt lds
    s_barrier
    s_add_u32 s60, s37, 4096
    s_add_u32 m0, s36, 1024
    s_nop 0
    buffer_load_dwordx4 v5, s[44:47], s60 offen nt lds
    s_add_u32 s60, s37, 8192
    s_add_u32 m0, s36, 2048
    s_nop 0
    buffer_load_dwordx4 v6, s[44:47], s60 offen nt lds
    s_add_u32 s60, s37, 12288
    s_add_u32 m0, s36, 3072
    s_nop 0
    buffer_load_dwordx4 v7, s[44:47], s60 offen nt lds
    v_lshlrev_b32 v111, 13, v2
    v_lshl_add_u32 v111, v3, 4, v111
    s_lshl_b32 s60, s33, 11
    s_add_u32 s60, s60, 131072
    v_add_u32 v111, s60, v111
    s_lshl_b32 s60, s33, 5
    s_and_b32 s60, s60, 0x30
    v_xor_b32 v111, s60, v111
    v_xor_b32 v116, 0, v111
    v_xor_b32 v117, 64, v111
    v_xor_b32 v118, 128, v111
    v_xor_b32 v119, 192, v111
    v_xor_b32 v120, 16, v111
    v_xor_b32 v121, 80, v111
    v_xor_b32 v122, 144, v111
    v_xor_b32 v123, 208, v111
    v_and_b32 v2, 31, v1
    v_lshrrev_b32 v3, 5, v1
    v_and_b32 v110, 3, v2
    v_lshlrev_b32 v110, 2, v110
    v_bfe_u32 v111, v2, 2, 2
    v_or_b32 v110, v110, v111
    v_xor_b32 v110, v110, v3
    v_lshlrev_b32 v110, 4, v110
    v_lshl_add_u32 v110, v2, 8, v110
    v_xor_b32 v16, 0, v110
    v_add_u32 v8, s36, v16
    v_add_u32 v16, 131072, v16
    v_xor_b32 v17, 32, v110
    v_add_u32 v9, s36, v17
    v_add_u32 v17, 131072, v17
    v_xor_b32 v18, 64, v110
    v_add_u32 v10, s36, v18
    v_add_u32 v18, 131072, v18
    v_xor_b32 v19, 96, v110
    v_add_u32 v11, s36, v19
    v_add_u32 v19, 131072, v19
    v_xor_b32 v20, 128, v110
    v_add_u32 v12, s36, v20
    v_add_u32 v20, 131072, v20
    v_xor_b32 v21, 160, v110
    v_add_u32 v13, s36, v21
    v_add_u32 v21, 131072, v21
    v_xor_b32 v22, 192, v110
    v_add_u32 v14, s36, v22
    v_add_u32 v22, 131072, v22
    v_xor_b32 v23, 224, v110
    v_add_u32 v15, s36, v23
    v_add_u32 v23, 131072, v23
    v_mov_b32 v104, 163584
    v_mov_b32 v105, 1
    v_mov_b32 v108, 16
    v_mov_b32 v109, 0x100
    v_lshlrev_b32 v112, 2, v2
    v_add_u32 v112, 131072, v112
    s_lshl_b32 s60, s33, 7
    v_add_u32 v114, s60, v112
    s_lshl_b32 s38, s33, 11
    s_add_u32 s38, s38, 139264
    v_lshl_add_u32 v113, v1, 4, s38
    v_lshlrev_b32 v115, 4, v1
    s_add_u32 s60, s37, 16384
    s_add_u32 m0, s36, 4096
    s_nop 0
    buffer_load_dwordx4 v4, s[44:47], s60 offen nt lds
    s_add_u32 s60, s37, 20480
    s_add_u32 m0, s36, 5120
    s_nop 0
    buffer_load_dwordx4 v5, s[44:47], s60 offen nt lds
    s_add_u32 s60, s37, 24576
    s_add_u32 m0, s36, 6144
    s_nop 0
    buffer_load_dwordx4 v6, s[44:47], s60 offen nt lds
    s_add_u32 s60, s37, 28672
    s_add_u32 m0, s36, 7168
    s_nop 0
    buffer_load_dwordx4 v7, s[44:47], s60 offen nt lds
    s_waitcnt lgkmcnt(0)
    s_add_u32 s32, s32, 1
    s_and_b32 s3, s32, 0xff
    s_bfe_u32 s52, s32, 0x10000
    s_bfe_u32 s60, s32, 0x10001
    s_lshl_b32 s60, s60, 16
    s_or_b32 s52, s52, s60
    s_bfe_u32 s53, s32, 0x10002
    s_bfe_u32 s60, s32, 0x10003
    s_lshl_b32 s60, s60, 16
    s_or_b32 s53, s53, s60
    s_bfe_u32 s54, s32, 0x10004
    s_bfe_u32 s60, s32, 0x10005
    s_lshl_b32 s60, s60, 16
    s_or_b32 s54, s54, s60
    s_bfe_u32 s55, s32, 0x10006
    s_bfe_u32 s60, s32, 0x10007
    s_lshl_b32 s60, s60, 16
    s_or_b32 s55, s55, s60
    s_lshr_b32 s60, s34, 6
    s_lshl_b32 s60, s60, 15
    s_lshl_b32 s63, s33, 13
    s_add_u32 s60, s60, s63
    s_add_u32 s63, s60, 65536
    s_add_u32 s59, s63, 4096
    s_lshr_b32 s56, s34, 6
    s_lshl_b32 s56, s56, 15
    s_add_u32 s56, s56, 97280
    s_cmp_eq_u32 s33, 3
    s_cselect_b32 s39, 0x7fffffff, -1
    s_lshl_b32 s60, s33, 12
    s_add_u32 s58, s60, 262144
    v_lshlrev_b32 v25, 7, v1
    s_add_u32 s60, s37, 256
    s_add_u32 m0, s36, 8192
    s_nop 0
    buffer_load_dwordx4 v4, s[44:47], s60 offen nt lds
    s_add_u32 s60, s37, 4352
    s_add_u32 m0, s36, 9216
    s_nop 0
    buffer_load_dwordx4 v5, s[44:47], s60 offen nt lds
    s_add_u32 s60, s37, 8448
    s_add_u32 m0, s36, 10240
    s_nop 0
    buffer_load_dwordx4 v6, s[44:47], s60 offen nt lds
    s_add_u32 s60, s37, 12544
    s_add_u32 m0, s36, 11264
    s_nop 0
    buffer_load_dwordx4 v7, s[44:47], s60 offen nt lds
    s_add_u32 s60, s37, 16640
    s_add_u32 m0, s36, 12288
    s_nop 0
    buffer_load_dwordx4 v4, s[44:47], s60 offen nt lds
    s_add_u32 s60, s37, 20736
    s_add_u32 m0, s36, 13312
    s_nop 0
    buffer_load_dwordx4 v5, s[44:47], s60 offen nt lds
    s_add_u32 s60, s37, 24832
    s_add_u32 m0, s36, 14336
    s_nop 0
    buffer_load_dwordx4 v6, s[44:47], s60 offen nt lds
    s_add_u32 s60, s37, 28928
    s_add_u32 m0, s36, 15360
    s_nop 0
    buffer_load_dwordx4 v7, s[44:47], s60 offen nt lds
    s_add_u32 s60, s37, 512
    s_add_u32 m0, s36, 16384
    s_nop 0
    buffer_load_dwordx4 v4, s[44:47], s60 offen nt lds
    s_add_u32 s60, s37, 4608
    s_add_u32 m0, s36, 17408
    s_nop 0
    buffer_load_dwordx4 v5, s[44:47], s60 offen nt lds
    s_add_u32 s60, s37, 8704
    s_add_u32 m0, s36, 18432
    s_nop 0
    buffer_load_dwordx4 v6, s[44:47], s60 offen nt lds
    s_add_u32 s60, s37, 12800
    s_add_u32 m0, s36, 19456
    s_nop 0
    buffer_load_dwordx4 v7, s[44:47], s60 offen nt lds
    s_add_u32 s60, s37, 16896
    s_add_u32 m0, s36, 20480
    s_nop 0
    buffer_load_dwordx4 v4, s[44:47], s60 offen nt lds
    s_add_u32 s60, s37, 20992
    s_add_u32 m0, s36, 21504
    s_nop 0
    buffer_load_dwordx4 v5, s[44:47], s60 offen nt lds
    s_add_u32 s60, s37, 25088
    s_add_u32 m0, s36, 22528
    s_nop 0
    buffer_load_dwordx4 v6, s[44:47], s60 offen nt lds
    s_add_u32 s60, s37, 29184
    s_add_u32 m0, s36, 23552
    s_nop 0
    buffer_load_dwordx4 v7, s[44:47], s60 offen nt lds
    s_add_u32 s60, s37, 768
    s_add_u32 m0, s36, 24576
    s_nop 0
    buffer_load_dwordx4 v4, s[44:47], s60 offen nt lds
    s_add_u32 s60, s37, 4864
    s_add_u32 m0, s36, 25600
    s_nop 0
    buffer_load_dwordx4 v5, s[44:47], s60 offen nt lds
    s_add_u32 s60, s37, 8960
    s_add_u32 m0, s36, 26624
    s_nop 0
    buffer_load_dwordx4 v6, s[44:47], s60 offen nt lds
    s_add_u32 s60, s37, 13056
    s_add_u32 m0, s36, 27648
    s_nop 0
    buffer_load_dwordx4 v7, s[44:47], s60 offen nt lds
    s_add_u32 s60, s37, 17152
    s_add_u32 m0, s36, 28672
    s_nop 0
    buffer_load_dwordx4 v4, s[44:47], s60 offen nt lds
    s_add_u32 s60, s37, 21248
    s_add_u32 m0, s36, 29696
    s_nop 0
    buffer_load_dwordx4 v5, s[44:47], s60 offen nt lds
    s_add_u32 s60, s37, 25344
    s_add_u32 m0, s36, 30720
    s_nop 0
    buffer_load_dwordx4 v6, s[44:47], s60 offen nt lds
    s_add_u32 s60, s37, 29440
    s_add_u32 m0, s36, 31744
    s_nop 0
    buffer_load_dwordx4 v7, s[44:47], s60 offen nt lds
    s_mov_b32 s61, 0
    s_mov_b32 exec_hi, 0
    buffer_load_dword v24, v25, s[40:43], s58 offen sc1
    s_mov_b32 s57, 24
    s_mov_b64 exec, -1
    v_mov_b32 v110, 0x1
    s_waitcnt vmcnt(25)
    s_mov_b64 exec, 1
    ds_add_u32 v104, v110 offset:12
    s_mov_b64 exec, -1
    ds_read_b128 v[128:131], v8 offset:0
    ds_read_b128 v[132:135], v9 offset:0
    ds_read_b128 v[136:139], v10 offset:0
    ds_read_b128 v[140:143], v11 offset:0
    ds_read_b128 v[144:147], v12 offset:0
    ds_read_b128 v[148:151], v13 offset:0
    ds_read_b128 v[152:155], v14 offset:0
    ds_read_b128 v[156:159], v15 offset:0
    v_mov_b32 v110, 0x10
    s_waitcnt vmcnt(17)
    s_mov_b64 exec, 1
    ds_add_u32 v104, v110 offset:12
    s_mov_b64 exec, -1
    ds_read_b128 v[160:163], v8 offset:8192
    ds_read_b128 v[164:167], v9 offset:8192
    ds_read_b128 v[168:171], v10 offset:8192
    ds_read_b128 v[172:175], v11 offset:8192
    ds_read_b128 v[176:179], v12 offset:8192
    s_waitcnt lgkmcnt(14)
    ds_read_b128 v[180:183], v13 offset:8192
    s_waitcnt lgkmcnt(14)
    ds_read_b128 v[184:187], v14 offset:8192
    s_waitcnt lgkmcnt(14)
    ds_read_b128 v[188:191], v15 offset:8192
    v_mov_b32 v110, 0x100
    s_waitcnt vmcnt(9)
    s_mov_b64 exec, 1
    s_waitcnt lgkmcnt(14)
    ds_add_u32 v104, v110 offset:12
    s_mov_b64 exec, -1
    s_waitcnt lgkmcnt(14)
    ds_read_b128 v[192:195], v8 offset:16384
    s_waitcnt lgkmcnt(14)
    ds_read_b128 v[196:199], v9 offset:16384
    s_waitcnt lgkmcnt(14)
    ds_read_b128 v[200:203], v10 offset:16384
    s_waitcnt lgkmcnt(14)
    ds_read_b128 v[204:207], v11 offset:16384
    s_waitcnt lgkmcnt(14)
    ds_read_b128 v[208:211], v12 offset:16384
    s_waitcnt lgkmcnt(14)
    ds_read_b128 v[212:215], v13 offset:16384
    s_waitcnt lgkmcnt(14)
    ds_read_b128 v[216:219], v14 offset:16384
    s_waitcnt lgkmcnt(14)
    ds_read_b128 v[220:223], v15 offset:16384
    v_mov_b32 v110, 0x1000
    s_waitcnt vmcnt(1)
    s_mov_b64 exec, 1
    s_waitcnt lgkmcnt(14)
    ds_add_u32 v104, v110 offset:12
    s_mov_b64 exec, -1
    s_waitcnt lgkmcnt(14)
    ds_read_b128 v[224:227], v8 offset:24576
    s_waitcnt lgkmcnt(14)
    ds_read_b128 v[228:231], v9 offset:24576
    s_waitcnt lgkmcnt(14)
    ds_read_b128 v[232:235], v10 offset:24576
    s_waitcnt lgkmcnt(14)
    ds_read_b128 v[236:239], v11 offset:24576
    s_waitcnt lgkmcnt(14)
    ds_read_b128 v[240:243], v12 offset:24576
    s_waitcnt lgkmcnt(14)
    ds_read_b128 v[244:247], v13 offset:24576
    s_waitcnt lgkmcnt(14)
    ds_read_b128 v[248:251], v14 offset:24576
    s_waitcnt lgkmcnt(14)
    ds_read_b128 v[252:255], v15 offset:24576
    s_mov_b64 exec, 1
    s_waitcnt lgkmcnt(14)
    ds_add_u32 v104, v108 offset:0
    s_mov_b64 exec, -1
    s_mov_b32 exec_hi, 0
    s_branch L_hpc_10
L_hp_8:
    buffer_load_dword v24, v25, s[40:43], s58 offen sc1
L_hpc_10:
    s_waitcnt vmcnt(0)
    v_cmp_eq_u32 vcc, s32, v24
    s_bcnt1_i32_b32 s60, vcc_lo
    s_cmp_ge_u32 s60, s57
    s_cbranch_scc1 L_hpd_9
    s_mov_b32 s57, 32
    s_add_u32 s61, s61, 1
    s_cmp_gt_u32 s61, s62
    s_cbranch_scc1 L_hpd_9
    s_sleep 2
    s_branch L_hp_8
L_hpd_9:
    s_mov_b64 exec, -1
    s_mov_b32 s61, 0
    buffer_load_dwordx4 v[72:75], v115, s[40:43], s63 offen offset:0
    buffer_load_dwordx4 v[76:79], v115, s[40:43], s63 offen offset:1024
    buffer_load_dwordx4 v[80:83], v115, s[40:43], s63 offen offset:2048
    buffer_load_dwordx4 v[84:87], v115, s[40:43], s63 offen offset:3072
    buffer_load_dwordx4 v[88:91], v115, s[40:43], s59 offen offset:0
    buffer_load_dwordx4 v[92:95], v115, s[40:43], s59 offen offset:1024
    buffer_load_dwordx4 v[96:99], v115, s[40:43], s59 offen offset:2048
    buffer_load_dwordx4 v[100:103], v115, s[40:43], s59 offen offset:3072
    v_mov_b32 v124, s52
    v_mov_b32 v125, s53
    v_mov_b32 v126, s54
    v_mov_b32 v127, s55
    s_mov_b32 exec_lo, 0
    s_mov_b32 exec_hi, 0xf0000000
    buffer_load_dwordx4 v[124:127], v115, s[40:43], s56 offen
    s_mov_b64 exec, -1
    s_mov_b64 exec, 1
    s_waitcnt lgkmcnt(14)
    ds_add_u32 v104, v109 offset:0
    s_mov_b64 exec, -1
L_qf_7:
    s_waitcnt vmcnt(8)
    v_xor_b32 v72, s52, v72
    v_xor_b32 v73, s53, v73
    v_xor_b32 v74, s54, v74
    v_xor_b32 v75, s55, v75
    ds_write_b128 v116, v[72:75] offset:0
    v_or3_b32 v110, v72, v73, v74
    v_mov_b32 v111, v75
    s_waitcnt vmcnt(7)
    v_xor_b32 v76, s52, v76
    v_xor_b32 v77, s53, v77
    v_xor_b32 v78, s54, v78
    v_xor_b32 v79, s55, v79
    ds_write_b128 v117, v[76:79] offset:256
    v_or3_b32 v110, v110, v76, v77
    v_or3_b32 v111, v111, v78, v79
    s_waitcnt vmcnt(6)
    v_xor_b32 v80, s52, v80
    v_xor_b32 v81, s53, v81
    v_xor_b32 v82, s54, v82
    v_xor_b32 v83, s55, v83
    ds_write_b128 v118, v[80:83] offset:512
    v_or3_b32 v110, v110, v80, v81
    v_or3_b32 v111, v111, v82, v83
    s_waitcnt vmcnt(5)
    v_xor_b32 v84, s52, v84
    v_xor_b32 v85, s53, v85
    v_xor_b32 v86, s54, v86
    v_xor_b32 v87, s55, v87
    ds_write_b128 v119, v[84:87] offset:768
    v_or3_b32 v110, v110, v84, v85
    v_or3_b32 v111, v111, v86, v87
    s_waitcnt vmcnt(4)
    v_xor_b32 v88, s52, v88
    v_xor_b32 v89, s53, v89
    v_xor_b32 v90, s54, v90
    v_xor_b32 v91, s55, v91
    ds_write_b128 v120, v[88:91] offset:1024
    v_or3_b32 v110, v110, v88, v89
    v_or3_b32 v111, v111, v90, v91
    s_waitcnt vmcnt(3)
    v_xor_b32 v92, s52, v92
    v_xor_b32 v93, s53, v93
    v_xor_b32 v94, s54, v94
    v_xor_b32 v95, s55, v95
    ds_write_b128 v121, v[92:95] offset:1280
    v_or3_b32 v110, v110, v92, v93
    v_or3_b32 v111, v111, v94, v95
    s_waitcnt vmcnt(2)
    v_xor_b32 v96, s52, v96
    v_xor_b32 v97, s53, v97
    v_xor_b32 v98, s54, v98
    v_xor_b32 v99, s55, v99
    ds_write_b128 v122, v[96:99] offset:1536
    v_or3_b32 v110, v110, v96, v97
    v_or3_b32 v111, v111, v98, v99
    s_waitcnt vmcnt(1)
    v_xor_b32 v100, s52, v100
    v_xor_b32 v101, s53, v101
    v_xor_b32 v102, s54, v102
    v_xor_b32 v103, s55, v103
    s_mov_b32 exec_hi, s39
    ds_write_b128 v123, v[100:103] offset:1792
    s_mov_b64 exec, -1
    v_or3_b32 v110, v110, v100, v101
    v_or3_b32 v111, v111, v102, v103
    s_waitcnt vmcnt(0)
    v_xor_b32 v124, s52, v124
    v_xor_b32 v125, s53, v125
    v_xor_b32 v126, s54, v126
    v_xor_b32 v127, s55, v127
    v_or3_b32 v111, v111, v124, v125
    v_or3_b32 v110, v110, v126, v127
    v_or_b32 v110, v110, v111
    v_and_b32 v110, 0x10001, v110
    v_cmp_ne_u32 vcc, 0, v110
    s_cbranch_vccnz L_qg_11
L_qgd_12:
    s_mov_b64 exec, 1
    s_waitcnt lgkmcnt(14)
    ds_add_u32 v104, v105 offset:4
    s_mov_b64 exec, -1
    s_branch L_pg3
.p2align 12
L_stub3:
    s_branch L_ret3
L_pg3:
    s_mov_b32 s61, 0
L_sp_13:
    ds_read_b32 v110, v104 offset:4
    s_waitcnt lgkmcnt(0)
    v_cmp_ne_u32 vcc, 4, v110
    s_cbranch_vccz L_spd_14
    s_add_u32 s61, s61, 1
    s_cmp_gt_u32 s61, s62
    s_cbranch_scc1 L_spd_14
    s_branch L_sp_13
L_spd_14:
    ds_read_b128 v[40:43], v16 offset:0
    ds_read_b128 v[44:47], v17 offset:0
    ds_read_b128 v[48:51], v18 offset:0
    ds_read_b128 v[52:55], v19 offset:0
    ds_read_b128 v[56:59], v20 offset:0
    ds_read_b128 v[60:63], v21 offset:0
    ds_read_b128 v[64:67], v22 offset:0
    ds_read_b128 v[68:71], v23 offset:0
    s_waitcnt lgkmcnt(7)
    v_mfma_f32_32x32x16_bf16 v[24:39], v[128:131], v[40:43], 0
    ds_read_b128 v[128:131], v16 offset:8192
    s_waitcnt lgkmcnt(7)
    v_mfma_f32_32x32x16_bf16 v[24:39], v[132:135], v[44:47], v[24:39]
    ds_read_b128 v[132:135], v17 offset:8192
    s_waitcnt lgkmcnt(7)
    v_mfma_f32_32x32x16_bf16 v[24:39], v[136:139], v[48:51], v[24:39]
    ds_read_b128 v[136:139], v18 offset:8192
    s_waitcnt lgkmcnt(7)
    v_mfma_f32_32x32x16_bf16 v[24:39], v[140:143], v[52:55], v[24:39]
    ds_read_b128 v[140:143], v19 offset:8192
    s_waitcnt lgkmcnt(7)
    v_mfma_f32_32x32x16_bf16 v[24:39], v[144:147], v[56:59], v[24:39]
    ds_read_b128 v[144:147], v20 offset:8192
    s_waitcnt lgkmcnt(7)
    v_mfma_f32_32x32x16_bf16 v[24:39], v[148:151], v[60:63], v[24:39]
    ds_read_b128 v[148:151], v21 offset:8192
    s_waitcnt lgkmcnt(7)
    v_mfma_f32_32x32x16_bf16 v[24:39], v[152:155], v[64:67], v[24:39]
    ds_read_b128 v[152:155], v22 offset:8192
    s_waitcnt lgkmcnt(7)
    v_mfma_f32_32x32x16_bf16 v[24:39], v[156:159], v[68:71], v[24:39]
    ds_read_b128 v[156:159], v23 offset:8192
    s_mov_b64 exec, 1
    ds_add_u32 v104, v105 offset:8
    s_mov_b64 exec, -1
    s_waitcnt lgkmcnt(8)
    v_mfma_f32_32x32x16_bf16 v[24:39], v[160:163], v[128:131], v[24:39]
    ds_read_b128 v[160:163], v16 offset:16384
    s_waitcnt lgkmcnt(8)
    v_mfma_f32_32x32x16_bf16 v[24:39], v[164:167], v[132:135], v[24:39]
    ds_read_b128 v[164:167], v17 offset:16384
    s_waitcnt lgkmcnt(8)
    v_mfma_f32_32x32x16_bf16 v[24:39], v[168:171], v[136:139], v[24:39]
    ds_read_b128 v[168:171], v18 offset:16384
    s_waitcnt lgkmcnt(8)
    v_mfma_f32_32x32x16_bf16 v[24:39], v[172:175], v[140:143], v[24:39]
    ds_read_b128 v[172:175], v19 offset:16384
    s_waitcnt lgkmcnt(8)
    v_mfma_f32_32x32x16_bf16 v[24:39], v[176:179], v[144:147], v[24:39]
    ds_read_b128 v[176:179], v20 offset:16384
    s_waitcnt lgkmcnt(8)
    v_mfma_f32_32x32x16_bf16 v[24:39], v[180:183], v[148:151], v[24:39]
    ds_read_b128 v[180:183], v21 offset:16384
    s_waitcnt lgkmcnt(8)
    v_mfma_f32_32x32x16_bf16 v[24:39], v[184:187], v[152:155], v[24:39]
    ds_read_b128 v[184:187], v22 offset:16384
    s_waitcnt lgkmcnt(8)
    v_mfma_f32_32x32x16_bf16 v[24:39], v[188:191], v[156:159], v[24:39]
    ds_read_b128 v[188:191], v23 offset:16384
    s_waitcnt lgkmcnt(7)
    v_mfma_f32_32x32x16_bf16 v[24:39], v[192:195], v[160:163], v[24:39]
    ds_read_b128 v[192:195], v16 offset:24576
    s_waitcnt lgkmcnt(7)
    v_mfma_f32_32x32x16_bf16 v[24:39], v[196:199], v[164:167], v[24:39]
    ds_read_b128 v[196:199], v17 offset:24576
    s_waitcnt lgkmcnt(7)
    v_mfma_f32_32x32x16_bf16 v[24:39], v[200:203], v[168:171], v[24:39]
    ds_read_b128 v[200:203], v18 offset:24576
    s_waitcnt lgkmcnt(7)
    v_mfma_f32_32x32x16_bf16 v[24:39], v[204:207], v[172:175], v[24:39]
    ds_read_b128 v[204:207], v19 offset:24576
    s_waitcnt lgkmcnt(7)
    v_mfma_f32_32x32x16_bf16 v[24:39], v[208:211], v[176:179], v[24:39]
    ds_read_b128 v[208:211], v20 offset:24576
    s_waitcnt lgkmcnt(7)
    v_mfma_f32_32x32x16_bf16 v[24:39], v[212:215], v[180:183], v[24:39]
    ds_read_b128 v[212:215], v21 offset:24576
    s_waitcnt lgkmcnt(7)
    v_mfma_f32_32x32x16_bf16 v[24:39], v[216:219], v[184:187], v[24:39]
    ds_read_b128 v[216:219], v22 offset:24576
    s_waitcnt lgkmcnt(7)
    v_mfma_f32_32x32x16_bf16 v[24:39], v[220:223], v[188:191], v[24:39]
    ds_read_b128 v[220:223], v23 offset:24576
    s_waitcnt lgkmcnt(7)
    v_mfma_f32_32x32x16_bf16 v[24:39], v[224:227], v[192:195], v[24:39]
    ds_read_b32 v111, v104 offset:8
    s_waitcnt lgkmcnt(7)
    v_mfma_f32_32x32x16_bf16 v[24:39], v[228:231], v[196:199], v[24:39]
    s_waitcnt lgkmcnt(6)
    v_mfma_f32_32x32x16_bf16 v[24:39], v[232:235], v[200:203], v[24:39]
    s_waitcnt lgkmcnt(5)
    v_mfma_f32_32x32x16_bf16 v[24:39], v[236:239], v[204:207], v[24:39]
    s_waitcnt lgkmcnt(0)
    v_and_b32 v111, 15, v111
    v_cmp_ne_u32 vcc, 4, v111
    s_cbranch_vccnz L_pk_15
L_pkb_16:
    v_mfma_f32_32x32x16_bf16 v[24:39], v[240:243], v[208:211], v[24:39]
    v_mfma_f32_32x32x16_bf16 v[24:39], v[244:247], v[212:215], v[24:39]
    v_mfma_f32_32x32x16_bf16 v[24:39], v[248:251], v[216:219], v[24:39]
    s_mov_b32 exec_lo, 0
    s_mov_b32 exec_hi, 0x80000000
    v_mov_b32 v220, v124
    v_mov_b32 v221, v125
    v_mov_b32 v222, v126
    v_mov_b32 v223, v127
    s_mov_b64 exec, -1
    s_nop 0
    v_mfma_f32_32x32x16_bf16 v[24:39], v[252:255], v[220:223], v[24:39]
    s_nop 7
    s_nop 3
    v_max3_f32 v106, v24, v25, v26
    v_max3_f32 v110, v27, v28, v29
    v_max3_f32 v106, v106, v30, v31
    v_max3_f32 v110, v110, v32, v33
    v_max3_f32 v106, v106, v34, v35
    v_max3_f32 v110, v110, v36, v37
    v_max3_f32 v106, v106, v38, v39
    v_max_f32 v106, v106, v110
    v_mov_b32 v110, v106
    s_nop 1
    v_permlane32_swap_b32 v106, v110
    s_nop 0
    v_max_f32 v106, v106, v110
    ds_write_b32 v114, v106 offset:0
    s_mov_b64 exec, 1
    ds_add_u32 v104, v108 offset:8
    s_mov_b64 exec, -1
    v_mov_b32 v80, v106
    v_pk_add_f32 v[24:25], v[24:25], v[106:107] op_sel_hi:[1,0] neg_lo:[0,1] neg_hi:[0,1]
    v_pk_add_f32 v[26:27], v[26:27], v[106:107] op_sel_hi:[1,0] neg_lo:[0,1] neg_hi:[0,1]
    v_pk_add_f32 v[28:29], v[28:29], v[106:107] op_sel_hi:[1,0] neg_lo:[0,1] neg_hi:[0,1]
    v_pk_add_f32 v[30:31], v[30:31], v[106:107] op_sel_hi:[1,0] neg_lo:[0,1] neg_hi:[0,1]
    v_pk_add_f32 v[32:33], v[32:33], v[106:107] op_sel_hi:[1,0] neg_lo:[0,1] neg_hi:[0,1]
    v_pk_add_f32 v[34:35], v[34:35], v[106:107] op_sel_hi:[1,0] neg_lo:[0,1] neg_hi:[0,1]
    v_pk_add_f32 v[36:37], v[36:37], v[106:107] op_sel_hi:[1,0] neg_lo:[0,1] neg_hi:[0,1]
    v_pk_add_f32 v[38:39], v[38:39], v[106:107] op_sel_hi:[1,0] neg_lo:[0,1] neg_hi:[0,1]
    v_exp_f32 v24, v24
    v_exp_f32 v25, v25
    v_exp_f32 v26, v26
    v_exp_f32 v27, v27
    v_exp_f32 v28, v28
    v_exp_f32 v29, v29
    ds_read_b32 v110, v104 offset:8
    ds_read2_b32 v[116:117], v112 offset0:0 offset1:32
    ds_read2_b32 v[118:119], v112 offset0:64 offset1:96
    v_exp_f32 v30, v30
    v_exp_f32 v31, v31
    v_exp_f32 v32, v32
    v_exp_f32 v33, v33
    v_exp_f32 v34, v34
    v_exp_f32 v35, v35
    v_exp_f32 v36, v36
    v_exp_f32 v37, v37
    v_exp_f32 v38, v38
    v_exp_f32 v39, v39
    s_mov_b32 s61, 0
L_mxc_20:
    s_waitcnt lgkmcnt(0)
    v_cmp_ne_u32 vcc, 0x44, v110
    v_max3_f32 v106, v116, v117, v118
    v_max_f32 v106, v106, v119
    s_cbranch_vccz L_mxd_19
L_mx_18:
    s_add_u32 s61, s61, 1
    s_cmp_gt_u32 s61, s62
    s_cbranch_scc1 L_mxd_19
    ds_read_b32 v110, v104 offset:8
    ds_read2_b32 v[116:117], v112 offset0:0 offset1:32
    ds_read2_b32 v[118:119], v112 offset0:64 offset1:96
    s_branch L_mxc_20
L_mxd_19:
    v_sub_f32 v82, v80, v106
    v_exp_f32 v82, v82
    s_nop 0
    v_pk_mul_f32 v[24:25], v[24:25], v[82:83] op_sel_hi:[1,0]
    v_pk_mul_f32 v[26:27], v[26:27], v[82:83] op_sel_hi:[1,0]
    v_cvt_pk_bf16_f32 v72, v24, v25
    v_pk_mul_f32 v[28:29], v[28:29], v[82:83] op_sel_hi:[1,0]
    v_cvt_pk_bf16_f32 v73, v26, v27
    v_pk_mul_f32 v[30:31], v[30:31], v[82:83] op_sel_hi:[1,0]
    v_cvt_pk_bf16_f32 v74, v28, v29
    v_pk_mul_f32 v[32:33], v[32:33], v[82:83] op_sel_hi:[1,0]
    v_cvt_pk_bf16_f32 v75, v30, v31
    ds_write_b128 v113, v[72:75]
    v_pk_mul_f32 v[34:35], v[34:35], v[82:83] op_sel_hi:[1,0]
    v_cvt_pk_bf16_f32 v76, v32, v33
    v_pk_mul_f32 v[36:37], v[36:37], v[82:83] op_sel_hi:[1,0]
    v_cvt_pk_bf16_f32 v77, v34, v35
    v_pk_mul_f32 v[38:39], v[38:39], v[82:83] op_sel_hi:[1,0]
    v_cvt_pk_bf16_f32 v78, v36, v37
    v_cvt_pk_bf16_f32 v79, v38, v39
    ds_write_b128 v113, v[76:79] offset:1024
    v_pk_add_f32 v[24:25], v[24:25], v[32:33]
    v_pk_add_f32 v[26:27], v[26:27], v[34:35]
    v_pk_add_f32 v[28:29], v[28:29], v[36:37]
    v_pk_add_f32 v[30:31], v[30:31], v[38:39]
    s_waitcnt lgkmcnt(0)
    s_barrier
    v_pk_add_f32 v[24:25], v[24:25], v[28:29]
    v_pk_add_f32 v[26:27], v[26:27], v[30:31]
    v_pk_add_f32 v[24:25], v[24:25], v[26:27]
    v_add_f32 v24, v24, v25
    v_mov_b32 v110, v24
    s_nop 1
    v_permlane32_swap_b32 v24, v110
    s_nop 0
    v_add_f32 v24, v24, v110
    ds_write_b32 v114, v24 offset:1536
    v_mov_b32 v107, v106
    s_barrier
    ds_read_b128 v[224:227], v8 offset:0
    ds_read_b128 v[228:231], v9 offset:0
    ds_read_b128 v[232:235], v10 offset:0
    ds_read_b128 v[236:239], v11 offset:0
    ds_read_b128 v[240:243], v12 offset:0
    ds_read_b128 v[244:247], v13 offset:0
    ds_read_b128 v[248:251], v14 offset:0
    ds_read_b128 v[252:255], v15 offset:0
    s_waitcnt lgkmcnt(7)
    v_mfma_f32_32x32x16_bf16 v[24:39], v[224:227], v[40:43], 0
    ds_read_b128 v[224:227], v8 offset:8192
    s_waitcnt lgkmcnt(7)
    v_mfma_f32_32x32x16_bf16 v[24:39], v[228:231], v[44:47], v[24:39]
    ds_read_b128 v[228:231], v9 offset:8192
    s_waitcnt lgkmcnt(7)
    v_mfma_f32_32x32x16_bf16 v[24:39], v[232:235], v[48:51], v[24:39]
    ds_read_b128 v[232:235], v10 offset:8192
    s_waitcnt lgkmcnt(7)
    v_mfma_f32_32x32x16_bf16 v[24:39], v[236:239], v[52:55], v[24:39]
    ds_read_b128 v[236:239], v11 offset:8192
    s_waitcnt lgkmcnt(7)
    v_mfma_f32_32x32x16_bf16 v[24:39], v[240:243], v[56:59], v[24:39]
    ds_read_b128 v[240:243], v12 offset:8192
    s_waitcnt lgkmcnt(7)
    v_mfma_f32_32x32x16_bf16 v[24:39], v[244:247], v[60:63], v[24:39]
    ds_read_b128 v[244:247], v13 offset:8192
    s_waitcnt lgkmcnt(7)
    v_mfma_f32_32x32x16_bf16 v[24:39], v[248:251], v[64:67], v[24:39]
    ds_read_b128 v[248:251], v14 offset:8192
    s_waitcnt lgkmcnt(7)
    v_mfma_f32_32x32x16_bf16 v[24:39], v[252:255], v[68:71], v[24:39]
    ds_read_b128 v[252:255], v15 offset:8192
    s_waitcnt lgkmcnt(7)
    v_mfma_f32_32x32x16_bf16 v[24:39], v[224:227], v[128:131], v[24:39]
    s_barrier
    ds_read_b128 v[224:227], v8 offset:16384
    s_waitcnt lgkmcnt(7)
    v_mfma_f32_32x32x16_bf16 v[24:39], v[228:231], v[132:135], v[24:39]
    ds_read_b128 v[228:231], v9 offset:16384
    s_waitcnt lgkmcnt(7)
    v_mfma_f32_32x32x16_bf16 v[24:39], v[232:235], v[136:139], v[24:39]
    ds_read_b128 v[232:235], v10 offset:16384
    s_waitcnt lgkmcnt(7)
    v_mfma_f32_32x32x16_bf16 v[24:39], v[236:239], v[140:143], v[24:39]
    ds_read_b128 v[236:239], v11 offset:16384
    s_waitcnt lgkmcnt(7)
    v_mfma_f32_32x32x16_bf16 v[24:39], v[240:243], v[144:147], v[24:39]
    ds_read_b128 v[240:243], v12 offset:16384
    s_waitcnt lgkmcnt(7)
    v_mfma_f32_32x32x16_bf16 v[24:39], v[244:247], v[148:151], v[24:39]
    ds_read_b128 v[244:247], v13 offset:16384
    s_waitcnt lgkmcnt(7)
    v_mfma_f32_32x32x16_bf16 v[24:39], v[248:251], v[152:155], v[24:39]
    ds_read_b128 v[248:251], v14 offset:16384
    s_waitcnt lgkmcnt(7)
    v_mfma_f32_32x32x16_bf16 v[24:39], v[252:255], v[156:159], v[24:39]
    ds_read_b128 v[252:255], v15 offset:16384
    s_waitcnt lgkmcnt(7)
    v_mfma_f32_32x32x16_bf16 v[24:39], v[224:227], v[160:163], v[24:39]
    s_barrier
    ds_read_b128 v[224:227], v8 offset:24576
    s_waitcnt lgkmcnt(7)
    v_mfma_f32_32x32x16_bf16 v[24:39], v[228:231], v[164:167], v[24:39]
    ds_read_b128 v[228:231], v9 offset:24576
    s_waitcnt lgkmcnt(7)
    v_mfma_f32_32x32x16_bf16 v[24:39], v[232:235], v[168:171], v[24:39]
    ds_read_b128 v[232:235], v10 offset:24576
    s_waitcnt lgkmcnt(7)
    v_mfma_f32_32x32x16_bf16 v[24:39], v[236:239], v[172:175], v[24:39]
    ds_read_b128 v[236:239], v11 offset:24576
    s_waitcnt lgkmcnt(7)
    v_mfma_f32_32x32x16_bf16 v[24:39], v[240:243], v[176:179], v[24:39]
    ds_read_b128 v[240:243], v12 offset:24576
    s_waitcnt lgkmcnt(7)
    v_mfma_f32_32x32x16_bf16 v[24:39], v[244:247], v[180:183], v[24:39]
    ds_read_b128 v[244:247], v13 offset:24576
    s_waitcnt lgkmcnt(7)
    v_mfma_f32_32x32x16_bf16 v[24:39], v[248:251], v[184:187], v[24:39]
    ds_read_b128 v[248:251], v14 offset:24576
    s_waitcnt lgkmcnt(7)
    v_mfma_f32_32x32x16_bf16 v[24:39], v[252:255], v[188:191], v[24:39]
    ds_read_b128 v[252:255], v15 offset:24576
    s_waitcnt lgkmcnt(7)
    v_mfma_f32_32x32x16_bf16 v[24:39], v[224:227], v[192:195], v[24:39]
    s_waitcnt lgkmcnt(6)
    v_mfma_f32_32x32x16_bf16 v[24:39], v[228:231], v[196:199], v[24:39]
    s_waitcnt lgkmcnt(5)
    v_mfma_f32_32x32x16_bf16 v[24:39], v[232:235], v[200:203], v[24:39]
    s_waitcnt lgkmcnt(4)
    v_mfma_f32_32x32x16_bf16 v[24:39], v[236:239], v[204:207], v[24:39]
    s_waitcnt lgkmcnt(3)
    v_mfma_f32_32x32x16_bf16 v[24:39], v[240:243], v[208:211], v[24:39]
    s_waitcnt lgkmcnt(2)
    v_mfma_f32_32x32x16_bf16 v[24:39], v[244:247], v[212:215], v[24:39]
    s_waitcnt lgkmcnt(1)
    v_mfma_f32_32x32x16_bf16 v[24:39], v[248:251], v[216:219], v[24:39]
    s_waitcnt lgkmcnt(0)
    v_mfma_f32_32x32x16_bf16 v[24:39], v[252:255], v[220:223], v[24:39]
    s_nop 7
    s_nop 3
    v_max3_f32 v106, v24, v25, v26
    v_max3_f32 v110, v27, v28, v29
    v_max3_f32 v106, v106, v30, v31
    v_max3_f32 v110, v110, v32, v33
    v_max3_f32 v106, v106, v34, v35
    v_max3_f32 v110, v110, v36, v37
    v_max3_f32 v106, v106, v38, v39
    v_max_f32 v106, v106, v110
    v_mov_b32 v110, v106
    s_nop 1
    v_permlane32_swap_b32 v106, v110
    s_nop 0
    v_max_f32 v106, v106, v110
    ds_write_b32 v114, v106 offset:512
    s_mov_b64 exec, 1
    ds_add_u32 v104, v109 offset:8
    s_mov_b64 exec, -1
    v_mov_b32 v80, v106
    v_pk_add_f32 v[24:25], v[24:25], v[106:107] op_sel_hi:[1,0] neg_lo:[0,1] neg_hi:[0,1]
    v_pk_add_f32 v[26:27], v[26:27], v[106:107] op_sel_hi:[1,0] neg_lo:[0,1] neg_hi:[0,1]
    v_pk_add_f32 v[28:29], v[28:29], v[106:107] op_sel_hi:[1,0] neg_lo:[0,1] neg_hi:[0,1]
    v_pk_add_f32 v[30:31], v[30:31], v[106:107] op_sel_hi:[1,0] neg_lo:[0,1] neg_hi:[0,1]
    v_pk_add_f32 v[32:33], v[32:33], v[106:107] op_sel_hi:[1,0] neg_lo:[0,1] neg_hi:[0,1]
    v_pk_add_f32 v[34:35], v[34:35], v[106:107] op_sel_hi:[1,0] neg_lo:[0,1] neg_hi:[0,1]
    v_pk_add_f32 v[36:37], v[36:37], v[106:107] op_sel_hi:[1,0] neg_lo:[0,1] neg_hi:[0,1]
    v_pk_add_f32 v[38:39], v[38:39], v[106:107] op_sel_hi:[1,0] neg_lo:[0,1] neg_hi:[0,1]
    v_exp_f32 v24, v24
    v_exp_f32 v25, v25
    v_exp_f32 v26, v26
    v_exp_f32 v27, v27
    v_exp_f32 v28, v28
    v_exp_f32 v29, v29
    ds_read_b32 v110, v104 offset:8
    ds_read2_b32 v[116:117], v112 offset0:128 offset1:160
    ds_read2_b32 v[118:119], v112 offset0:192 offset1:224
    v_exp_f32 v30, v30
    v_exp_f32 v31, v31
    v_exp_f32 v32, v32
    v_exp_f32 v33, v33
    v_exp_f32 v34, v34
    v_exp_f32 v35, v35
    v_exp_f32 v36, v36
    v_exp_f32 v37, v37
    v_exp_f32 v38, v38
    v_exp_f32 v39, v39
    s_mov_b32 s61, 0
L_mxc_23:
    s_waitcnt lgkmcnt(0)
    v_cmp_ne_u32 vcc, 0x444, v110
    v_max3_f32 v106, v116, v117, v118
    v_max_f32 v106, v106, v119
    s_cbranch_vccz L_mxd_22
L_mx_21:
    s_add_u32 s61, s61, 1
    s_cmp_gt_u32 s61, s62
    s_cbranch_scc1 L_mxd_22
    ds_read_b32 v110, v104 offset:8
    ds_read2_b32 v[116:117], v112 offset0:128 offset1:160
    ds_read2_b32 v[118:119], v112 offset0:192 offset1:224
    s_branch L_mxc_23
L_mxd_22:
    v_add_f32 v110, 0x41000000, v107
    v_cmp_gt_f32 vcc, v106, v110
    v_lshl_add_u32 v111, v2, 2, v112
    s_nop 0
    v_cndmask_b32 v106, v107, v106, vcc
    v_sub_f32 v82, v80, v106
    v_exp_f32 v82, v82
    v_sub_f32 v108, v107, v106
    v_exp_f32 v108, v108
    v_mov_b32 v109, v106
    v_pk_mul_f32 v[24:25], v[24:25], v[82:83] op_sel_hi:[1,0]
    v_pk_mul_f32 v[26:27], v[26:27], v[82:83] op_sel_hi:[1,0]
    v_cvt_pk_bf16_f32 v72, v24, v25
    v_pk_mul_f32 v[28:29], v[28:29], v[82:83] op_sel_hi:[1,0]
    v_cvt_pk_bf16_f32 v73, v26, v27
    v_pk_mul_f32 v[30:31], v[30:31], v[82:83] op_sel_hi:[1,0]
    v_cvt_pk_bf16_f32 v74, v28, v29
    v_pk_mul_f32 v[32:33], v[32:33], v[82:83] op_sel_hi:[1,0]
    v_cvt_pk_bf16_f32 v75, v30, v31
    ds_write_b128 v113, v[72:75]
    v_pk_mul_f32 v[34:35], v[34:35], v[82:83] op_sel_hi:[1,0]
    v_cvt_pk_bf16_f32 v76, v32, v33
    v_pk_mul_f32 v[36:37], v[36:37], v[82:83] op_sel_hi:[1,0]
    v_cvt_pk_bf16_f32 v77, v34, v35
    v_pk_mul_f32 v[38:39], v[38:39], v[82:83] op_sel_hi:[1,0]
    v_cvt_pk_bf16_f32 v78, v36, v37
    v_cvt_pk_bf16_f32 v79, v38, v39
    ds_write_b128 v113, v[76:79] offset:1024
    ds_write_b64 v111, v[108:109] offset:1024
    v_pk_add_f32 v[24:25], v[24:25], v[32:33]
    v_pk_add_f32 v[26:27], v[26:27], v[34:35]
    v_pk_add_f32 v[28:29], v[28:29], v[36:37]
    v_pk_add_f32 v[30:31], v[30:31], v[38:39]
    s_waitcnt lgkmcnt(0)
    s_barrier
    v_pk_add_f32 v[24:25], v[24:25], v[28:29]
    v_pk_add_f32 v[26:27], v[26:27], v[30:31]
    v_pk_add_f32 v[24:25], v[24:25], v[26:27]
    v_add_f32 v24, v24, v25
    v_mov_b32 v110, v24
    s_nop 1
    v_permlane32_swap_b32 v24, v110
    s_nop 0
    v_add_f32 v24, v24, v110
    ds_write_b32 v114, v24 offset:2048
    s_waitcnt lgkmcnt(0)
    s_barrier
    s_cmp_lg_u32 s33, 0
    s_cbranch_scc1 L_qk_noann
    ds_read_b32 v24, v112 offset:1536
    ds_read_b32 v25, v112 offset:2048
    ds_read_b32 v26, v112 offset:1664
    ds_read_b32 v27, v112 offset:2176
    ds_read_b32 v28, v112 offset:1792
    ds_read_b32 v29, v112 offset:2304
    ds_read_b32 v30, v112 offset:1920
    ds_read_b32 v31, v112 offset:2432
    v_mov_b32 v80, s32
    v_mov_b32 v81, 0
    s_lshl_b32 s60, s34, 7
    s_add_u32 s60, s60, 327680
    s_mov_b64 exec, 1
    buffer_store_dword v80, v81, s[40:43], s60 offen sc1
    s_mov_b64 exec, -1
    s_lshl_b32 s60, s34, 9
    s_add_u32 s60, s60, 524288
    v_mov_b32 v32, v106
    v_mov_b32 v33, s32
    v_mov_b32 v35, s32
    v_lshlrev_b32 v110, 4, v2
    s_waitcnt lgkmcnt(0)
    v_pk_add_f32 v[24:25], v[24:25], v[26:27]
    v_pk_add_f32 v[28:29], v[28:29], v[30:31]
    v_pk_add_f32 v[24:25], v[24:25], v[28:29]
    v_fma_f32 v34, v24, v108, v25
    s_mov_b32 exec_hi, 0
    buffer_store_dwordx4 v[32:35], v110, s[40:43], s60 offen sc1
    s_mov_b64 exec, -1
L_qk_noann:
    s_and_b32 s56, s34, 7
    s_lshr_b32 s60, s34, 4
    s_lshl_b32 s60, s60, 3
    s_add_u32 s56, s56, s60
    s_cmp_ge_u32 s56, 28
    s_cbranch_scc1 L_att_noffn
    s_lshl_b32 s56, s56, 1
    s_bfe_u32 s60, s34, 0x10003
    s_add_u32 s56, s56, s60
    s_branch L_pg4
.p2align 12
L_stub4:
    s_branch L_ret4
L_pg4:
    s_mov_b32 s48, s4
    s_mov_b32 s49, s5
    s_mov_b32 s50, 0x800
    s_mov_b32 s51, 0x20000
    s_and_b32 s60, s33, 1
    s_lshl_b32 s60, s60, 10
    v_lshlrev_b32 v16, 4, v1
    buffer_load_dwordx4 v[128:131], v16, s[48:51], s60 offen
    s_mov_b32 s48, s20
    s_mov_b32 s49, s21
    s_mov_b32 s50, 0xe00
    s_mov_b32 s51, 0x20000
    v_and_b32 v12, 31, v1
    v_lshlrev_b32 v12, 1, v12
    s_lshl_b32 s60, s56, 6
    buffer_load_ushort v16, v12, s[48:51], s60 offen
    v_lshrrev_b32 v8, 4, v1
    v_and_b32 v9, 15, v1
    v_lshrrev_b32 v10, 2, v9
    v_and_b32 v11, 3, v9
    s_lshl_b32 s38, s33, 14
    s_add_u32 s38, s38, 0x8000
    s_mov_b32 s48, s18
    s_mov_b32 s49, s19
    s_mov_b32 s50, 0x1c0000
    s_mov_b32 s51, 0x20000
    s_mov_b32 s8, s22
    s_mov_b32 s9, s23
    s_mov_b32 s10, 0x1c0000
    s_mov_b32 s11, 0x20000
    s_mul_i32 s58, s33, 458752
    s_lshl_b32 s60, s56, 6
    s_add_u32 s58, s58, s60
    s_lshl_b32 s59, s56, 15
    s_lshl_b32 s60, s33, 8
    s_add_u32 s59, s59, s60
    v_lshrrev_b32 v12, 2, v1
    v_and_b32 v13, 3, v1
    v_lshrrev_b32 v14, 5, v1
    v_lshlrev_b32 v14, 1, v14
    v_xor_b32 v13, v13, v14
    v_lshlrev_b32 v13, 4, v13
    s_movk_i32 s60, 3584
    v_mad_u32_u24 v15, v12, s60, v13
    v_and_b32 v12, 1, v8
    v_lshlrev_b32 v12, 1, v12
    v_lshrrev_b32 v13, 1, v11
    v_xor_b32 v12, v12, v13
    v_lshlrev_b32 v12, 4, v12
    v_and_b32 v14, 1, v11
    v_lshl_or_b32 v12, v14, 3, v12
    v_lshl_add_u32 v17, v8, 3, v10
    v_lshl_add_u32 v12, v17, 6, v12
    v_add_u32 v18, s38, v12
    v_xor_b32 v19, 32, v18
    v_and_b32 v12, 1, v8
    v_lshlrev_b32 v12, 1, v12
    v_lshl_or_b32 v12, v10, 2, v12
    v_xor_b32 v12, v12, v13
    v_lshlrev_b32 v12, 4, v12
    v_lshl_or_b32 v12, v14, 3, v12
    v_lshl_add_u32 v12, v17, 8, v12
    v_add_u32 v20, s38, v12
    v_xor_b32 v32, 0, v20
    v_xor_b32 v33, 16, v20
    v_xor_b32 v34, 32, v20
    v_xor_b32 v35, 48, v20
    v_xor_b32 v36, 64, v20
    v_xor_b32 v37, 80, v20
    v_xor_b32 v38, 96, v20
    v_xor_b32 v39, 112, v20
    v_xor_b32 v40, 128, v20
    v_xor_b32 v41, 144, v20
    v_xor_b32 v42, 160, v20
    v_xor_b32 v43, 176, v20
    v_xor_b32 v44, 192, v20
    v_xor_b32 v45, 208, v20
    v_xor_b32 v46, 224, v20
    v_xor_b32 v47, 240, v20
    v_and_b32 v12, 1, v9
    v_lshlrev_b32 v13, 4, v8
    v_lshl_add_u32 v21, v12, 10, v13
    s_lshl_b32 s60, s33, 8
    s_add_u32 s60, s60, 98304
    v_add_u32 v21, s60, v21
    s_lshl_b32 s39, s33, 7
    s_add_u32 s39, s39, 101376
    v_lshl_add_u32 v22, v12, 6, v13
    v_add_u32 v22, s39, v22
    v_lshl_add_u32 v23, v9, 7, v13
    s_lshl_b32 s60, s33, 8
    s_add_u32 s60, s60, 100352
    v_add_u32 v23, s60, v23
    v_lshl_add_u32 v24, v12, 11, v13
    v_lshrrev_b32 v12, 1, v9
    v_lshl_add_u32 v24, v12, 6, v24
    s_lshl_b32 s60, s33, 9
    v_add_u32 v24, s60, v24
    v_mov_b32 v25, 0xffffff00
    v_lshlrev_b32 v29, 2, v1
    v_add_u32 v29, 100352, v29
    v_lshl_add_u32 v30, v1, 1, s39
    s_lshl_b32 s57, s56, 12
    s_add_u32 s57, s57, 1572864
    s_mov_b32 s12, 0xcccccccc
    s_mov_b32 s13, 0xcccccccc
    s_mov_b32 s14, 0xf0f0f0f0
    s_mov_b32 s15, 0xf0f0f0f0
    s_mov_b32 s16, 0xff00ff00
    s_mov_b32 s17, 0xff00ff00
    s_cmp_eq_u32 s33, 0
    s_cbranch_scc1 L_ffn_noln
    s_waitcnt vmcnt(0)
    v_lshlrev_b32 v136, 16, v128
    v_and_b32 v137, 0xffff0000, v128
    v_lshlrev_b32 v138, 16, v129
    v_and_b32 v139, 0xffff0000, v129
    v_lshlrev_b32 v140, 16, v130
    v_and_b32 v141, 0xffff0000, v130
    v_lshlrev_b32 v142, 16, v131
    v_and_b32 v143, 0xffff0000, v131
    v_add_f32 v26, v136, v137
    v_add_f32 v27, v138, v139
    v_add_f32 v26, v26, v140
    v_add_f32 v27, v27, v141
    v_add_f32 v26, v26, v142
    v_add_f32 v27, v27, v143
    v_add_f32 v26, v26, v27
    s_nop 1
    v_add_f32_dpp v26, v26, v26 quad_perm:[1,0,3,2] row_mask:0xf bank_mask:0xf
    s_nop 1
    v_add_f32_dpp v26, v26, v26 quad_perm:[2,3,0,1] row_mask:0xf bank_mask:0xf
    s_nop 1
    v_add_f32_dpp v26, v26, v26 row_half_mirror row_mask:0xf bank_mask:0xf
    s_nop 1
    v_add_f32_dpp v26, v26, v26 row_mirror row_mask:0xf bank_mask:0xf
    v_mov_b32 v27, v26
    s_nop 1
    v_permlane16_swap_b32 v26, v27
    s_nop 0
    v_add_f32 v26, v26, v27
    v_mov_b32 v27, v26
    s_nop 1
    v_permlane32_swap_b32 v26, v27
    s_nop 0
    v_add_f32 v26, v26, v27
    v_mul_f32 v26, 0x3b000000, v26
    v_sub_f32 v144, v136, v26
    v_sub_f32 v145, v137, v26
    v_sub_f32 v146, v138, v26
    v_sub_f32 v147, v139, v26
    v_sub_f32 v148, v140, v26
    v_sub_f32 v149, v141, v26
    v_sub_f32 v150, v142, v26
    v_sub_f32 v151, v143, v26
    v_mul_f32 v28, v144, v144
    v_fmac_f32 v28, v145, v145
    v_fmac_f32 v28, v146, v146
    v_fmac_f32 v28, v147, v147
    v_fmac_f32 v28, v148, v148
    v_fmac_f32 v28, v149, v149
    v_fmac_f32 v28, v150, v150
    v_fmac_f32 v28, v151, v151
    s_nop 1
    v_add_f32_dpp v28, v28, v28 quad_perm:[1,0,3,2] row_mask:0xf bank_mask:0xf
    s_nop 1
    v_add_f32_dpp v28, v28, v28 quad_perm:[2,3,0,1] row_mask:0xf bank_mask:0xf
    s_nop 1
    v_add_f32_dpp v28, v28, v28 row_half_mirror row_mask:0xf bank_mask:0xf
    s_nop 1
    v_add_f32_dpp v28, v28, v28 row_mirror row_mask:0xf bank_mask:0xf
    v_mov_b32 v27, v28
    s_nop 1
    v_permlane16_swap_b32 v28, v27
    s_nop 0
    v_add_f32 v28, v28, v27
    v_mov_b32 v27, v28
    s_nop 1
    v_permlane32_swap_b32 v28, v27
    s_nop 0
    v_add_f32 v28, v28, v27
    v_mul_f32 v28, 0x3b000000, v28
    v_cvt_pk_bf16_f32 v26, v26, v26
    v_lshlrev_b32 v26, 16, v26
    v_cvt_pk_bf16_f32 v28, v28, v28
    v_lshlrev_b32 v28, 16, v28
    v_add_f32 v28, 0x3727c5ac, v28
    v_cvt_pk_bf16_f32 v28, v28, v28
    v_lshlrev_b32 v28, 16, v28
    v_sqrt_f32 v28, v28
    s_nop 0
    v_cvt_pk_bf16_f32 v28, v28, v28
    v_lshlrev_b32 v28, 16, v28
    v_rcp_f32 v28, v28
    v_sub_f32 v136, v136, v26
    v_sub_f32 v137, v137, v26
    v_sub_f32 v138, v138, v26
    v_sub_f32 v139, v139, v26
    v_sub_f32 v140, v140, v26
    v_sub_f32 v141, v141, v26
    v_sub_f32 v142, v142, v26
    v_sub_f32 v143, v143, v26
    v_cvt_pk_bf16_f32 v144, v136, v137
    v_cvt_pk_bf16_f32 v145, v138, v139
    v_cvt_pk_bf16_f32 v146, v140, v141
    v_cvt_pk_bf16_f32 v147, v142, v143
    v_lshlrev_b32 v136, 16, v144
    v_and_b32 v137, 0xffff0000, v144
    v_lshlrev_b32 v138, 16, v145
    v_and_b32 v139, 0xffff0000, v145
    v_lshlrev_b32 v140, 16, v146
    v_and_b32 v141, 0xffff0000, v146
    v_lshlrev_b32 v142, 16, v147
    v_and_b32 v143, 0xffff0000, v147
    v_mul_f32 v136, v136, v28
    v_mul_f32 v137, v137, v28
    v_mul_f32 v138, v138, v28
    v_mul_f32 v139, v139, v28
    v_mul_f32 v140, v140, v28
    v_mul_f32 v141, v141, v28
    v_mul_f32 v142, v142, v28
    v_mul_f32 v143, v143, v28
    v_cvt_pk_bf16_f32 v124, v136, v137
    v_cvt_pk_bf16_f32 v125, v138, v139
    v_cvt_pk_bf16_f32 v126, v140, v141
    v_cvt_pk_bf16_f32 v127, v142, v143
    s_and_b32 s60, s33, 1
    s_lshl_b32 s60, s60, 10
    s_add_u32 s60, s60, 98304
    v_lshl_add_u32 v12, v1, 4, s60
    ds_write_b128 v12, v[124:127]
    s_waitcnt lgkmcnt(0)
L_ffn_noln:
    s_barrier
    s_add_u32 s60, s58, 0
    s_add_u32 m0, s38, 0
    s_nop 0
    buffer_load_dwordx4 v15, s[48:51], s60 offen lds
    s_add_u32 s60, s58, 57344
    s_add_u32 m0, s38, 1024
    s_nop 0
    buffer_load_dwordx4 v15, s[48:51], s60 offen lds
    s_add_u32 s60, s58, 114688
    s_add_u32 m0, s38, 2048
    s_nop 0
    buffer_load_dwordx4 v15, s[48:51], s60 offen lds
    s_add_u32 s60, s58, 172032
    s_add_u32 m0, s38, 3072
    s_nop 0
    buffer_load_dwordx4 v15, s[48:51], s60 offen lds
    s_add_u32 s60, s58, 229376
    s_add_u32 m0, s38, 4096
    s_nop 0
    buffer_load_dwordx4 v15, s[48:51], s60 offen lds
    s_add_u32 s60, s58, 286720
    s_add_u32 m0, s38, 5120
    s_nop 0
    buffer_load_dwordx4 v15, s[48:51], s60 offen lds
    s_add_u32 s60, s58, 344064
    s_add_u32 m0, s38, 6144
    s_nop 0
    buffer_load_dwordx4 v15, s[48:51], s60 offen lds
    s_add_u32 s60, s58, 401408
    s_add_u32 m0, s38, 7168
    s_nop 0
    buffer_load_dwordx4 v15, s[48:51], s60 offen lds
    s_add_u32 s60, s59, 0
    s_add_u32 m0, s38, 8192
    s_nop 0
    buffer_load_dwordx4 v4, s[8:11], s60 offen lds
    s_add_u32 s60, s59, 4096
    s_add_u32 m0, s38, 9216
    s_nop 0
    buffer_load_dwordx4 v5, s[8:11], s60 offen lds
    s_add_u32 s60, s59, 8192
    s_add_u32 m0, s38, 10240
    s_nop 0
    buffer_load_dwordx4 v6, s[8:11], s60 offen lds
    s_add_u32 s60, s59, 12288
    s_add_u32 m0, s38, 11264
    s_nop 0
    buffer_load_dwordx4 v7, s[8:11], s60 offen lds
    s_add_u32 s60, s59, 16384
    s_add_u32 m0, s38, 12288
    s_nop 0
    buffer_load_dwordx4 v4, s[8:11], s60 offen lds
    s_add_u32 s60, s59, 20480
    s_add_u32 m0, s38, 13312
    s_nop 0
    buffer_load_dwordx4 v5, s[8:11], s60 offen lds
    s_add_u32 s60, s59, 24576
    s_add_u32 m0, s38, 14336
    s_nop 0
    buffer_load_dwordx4 v6, s[8:11], s60 offen lds
    s_add_u32 s60, s59, 28672
    s_add_u32 m0, s38, 15360
    s_nop 0
    buffer_load_dwordx4 v7, s[8:11], s60 offen lds
    s_waitcnt vmcnt(14)
    ds_read_b128 v[128:131], v21 offset:0
    ds_read_b64_tr_b16 v[144:145], v18 offset:0
    ds_read_b64_tr_b16 v[146:147], v18 offset:256
    ds_read_b64_tr_b16 v[148:149], v19 offset:0
    ds_read_b64_tr_b16 v[150:151], v19 offset:256
    s_waitcnt vmcnt(12)
    ds_read_b128 v[132:135], v21 offset:64
    ds_read_b64_tr_b16 v[152:153], v18 offset:2048
    ds_read_b64_tr_b16 v[154:155], v18 offset:2304
    ds_read_b64_tr_b16 v[156:157], v19 offset:2048
    ds_read_b64_tr_b16 v[158:159], v19 offset:2304
    s_waitcnt vmcnt(10)
    ds_read_b128 v[136:139], v21 offset:128
    ds_read_b64_tr_b16 v[160:161], v18 offset:4096
    ds_read_b64_tr_b16 v[162:163], v18 offset:4352
    ds_read_b64_tr_b16 v[164:165], v19 offset:4096
    ds_read_b64_tr_b16 v[166:167], v19 offset:4352
    s_waitcnt vmcnt(8)
    s_waitcnt lgkmcnt(14)
    ds_read_b128 v[140:143], v21 offset:192
    s_waitcnt lgkmcnt(14)
    ds_read_b64_tr_b16 v[168:169], v18 offset:6144
    s_waitcnt lgkmcnt(14)
    ds_read_b64_tr_b16 v[170:171], v18 offset:6400
    s_waitcnt lgkmcnt(14)
    ds_read_b64_tr_b16 v[172:173], v19 offset:6144
    s_waitcnt lgkmcnt(14)
    ds_read_b64_tr_b16 v[174:175], v19 offset:6400
    v_mfma_f32_16x16x32_bf16 v[192:195], v[144:147], v[128:131], 0
    v_mfma_f32_16x16x32_bf16 v[196:199], v[148:151], v[128:131], 0
    s_waitcnt lgkmcnt(12)
    v_mfma_f32_16x16x32_bf16 v[192:195], v[152:155], v[132:135], v[192:195]
    s_waitcnt lgkmcnt(10)
    v_mfma_f32_16x16x32_bf16 v[196:199], v[156:159], v[132:135], v[196:199]
    s_waitcnt lgkmcnt(7)
    v_mfma_f32_16x16x32_bf16 v[192:195], v[160:163], v[136:139], v[192:195]
    s_waitcnt lgkmcnt(5)
    v_mfma_f32_16x16x32_bf16 v[196:199], v[164:167], v[136:139], v[196:199]
    s_waitcnt lgkmcnt(2)
    v_mfma_f32_16x16x32_bf16 v[192:195], v[168:171], v[140:143], v[192:195]
    s_waitcnt lgkmcnt(0)
    v_mfma_f32_16x16x32_bf16 v[196:199], v[172:175], v[140:143], v[196:199]
    s_nop 5
    s_mov_b32 exec_lo, 0x00030003
    s_mov_b32 exec_hi, 0x00030003
    ds_write_b128 v23, v[192:195] offset:0
    ds_write_b128 v23, v[196:199] offset:64
    s_mov_b64 exec, -1
    s_waitcnt lgkmcnt(0)
    s_barrier
    ds_read_b32 v128, v29 offset:0
    ds_read_b32 v129, v29 offset:256
    ds_read_b32 v130, v29 offset:512
    ds_read_b32 v131, v29 offset:768
    s_waitcnt vmcnt(0)
    ds_read_b64_tr_b16 v[144:145], v32 offset:8192
    ds_read_b64_tr_b16 v[146:147], v33 offset:9216
    ds_read_b64_tr_b16 v[148:149], v34 offset:8192
    ds_read_b64_tr_b16 v[150:151], v35 offset:9216
    ds_read_b64_tr_b16 v[152:153], v36 offset:8192
    ds_read_b64_tr_b16 v[154:155], v37 offset:9216
    ds_read_b64_tr_b16 v[156:157], v38 offset:8192
    ds_read_b64_tr_b16 v[158:159], v39 offset:9216
    ds_read_b64_tr_b16 v[160:161], v40 offset:8192
    ds_read_b64_tr_b16 v[162:163], v41 offset:9216
    ds_read_b64_tr_b16 v[164:165], v42 offset:8192
    s_waitcnt lgkmcnt(14)
    ds_read_b64_tr_b16 v[166:167], v43 offset:9216
    s_waitcnt lgkmcnt(14)
    ds_read_b64_tr_b16 v[168:169], v44 offset:8192
    s_waitcnt lgkmcnt(14)
    ds_read_b64_tr_b16 v[170:171], v45 offset:9216
    s_waitcnt lgkmcnt(14)
    ds_read_b64_tr_b16 v[172:173], v46 offset:8192
    s_waitcnt lgkmcnt(14)
    ds_read_b64_tr_b16 v[174:175], v47 offset:9216
    v_lshlrev_b32 v16, 16, v16
    v_add_f32 v128, v128, v129
    v_add_f32 v130, v130, v131
    v_add_f32 v128, v128, v130
    v_cvt_pk_bf16_f32 v128, v128, v128
    v_lshlrev_b32 v128, 16, v128
    v_add_f32 v128, v128, v16
    v_cvt_pk_bf16_f32 v128, v128, v128
    v_lshlrev_b32 v128, 16, v128
    v_mul_f32 v129, v128, v128
    v_mul_f32 v129, v129, v128
    v_mul_f32 v129, 0x3d372713, v129
    v_add_f32 v129, v129, v128
    v_mul_f32 v129, 0xc0135761, v129
    v_exp_f32 v129, v129
    s_nop 0
    v_add_f32 v129, 1.0, v129
    v_rcp_f32 v129, v129
    s_nop 0
    v_mul_f32 v128, v128, v129
    v_cvt_pk_bf16_f32 v128, v128, v128
    s_waitcnt lgkmcnt(14)
    ds_write_b16 v30, v128
    s_waitcnt lgkmcnt(14)
    ds_read_b128 v[132:135], v22
    s_cmp_lg_u32 s33, 3
    s_cbranch_scc1 L_ya_24
    v_mov_b32 v26, s32
    v_mov_b32 v27, 0
    s_lshl_b32 s60, s56, 7
    s_add_u32 s60, s60, 360448
    s_mov_b64 exec, 1
    buffer_store_dword v26, v27, s[40:43], s60 offen sc1
    s_mov_b64 exec, -1
L_ya_24:
    s_waitcnt lgkmcnt(0)
    v_mfma_f32_16x16x32_bf16 v[192:195], v[144:147], v[132:135], 0
    v_mfma_f32_16x16x32_bf16 v[196:199], v[148:151], v[132:135], 0
    v_mfma_f32_16x16x32_bf16 v[200:203], v[152:155], v[132:135], 0
    v_mfma_f32_16x16x32_bf16 v[204:207], v[156:159], v[132:135], 0
    v_mfma_f32_16x16x32_bf16 v[208:211], v[160:163], v[132:135], 0
    v_mfma_f32_16x16x32_bf16 v[212:215], v[164:167], v[132:135], 0
    v_mfma_f32_16x16x32_bf16 v[216:219], v[168:171], v[132:135], 0
    v_mfma_f32_16x16x32_bf16 v[220:223], v[172:175], v[132:135], 0
    s_nop 1
    v_cndmask_b32 v192, v192, v196, s[12:13]
    v_cndmask_b32 v193, v193, v197, s[12:13]
    v_cndmask_b32 v194, v194, v198, s[12:13]
    v_cndmask_b32 v195, v195, v199, s[12:13]
    v_cndmask_b32 v200, v200, v204, s[12:13]
    v_cndmask_b32 v201, v201, v205, s[12:13]
    v_cndmask_b32 v202, v202, v206, s[12:13]
    v_cndmask_b32 v203, v203, v207, s[12:13]
    s_nop 0
    v_cndmask_b32 v208, v208, v212, s[12:13]
    v_cndmask_b32 v209, v209, v213, s[12:13]
    v_cndmask_b32 v210, v210, v214, s[12:13]
    v_cndmask_b32 v211, v211, v215, s[12:13]
    v_cndmask_b32 v216, v216, v220, s[12:13]
    v_cndmask_b32 v217, v217, v221, s[12:13]
    v_cndmask_b32 v218, v218, v222, s[12:13]
    v_cndmask_b32 v219, v219, v223, s[12:13]
    v_cndmask_b32 v192, v192, v200, s[14:15]
    v_cndmask_b32 v193, v193, v201, s[14:15]
    v_cndmask_b32 v194, v194, v202, s[14:15]
    v_cndmask_b32 v195, v195, v203, s[14:15]
    v_cndmask_b32 v208, v208, v216, s[14:15]
    v_cndmask_b32 v209, v209, v217, s[14:15]
    v_cndmask_b32 v210, v210, v218, s[14:15]
    v_cndmask_b32 v211, v211, v219, s[14:15]
    v_cndmask_b32 v192, v192, v208, s[16:17]
    v_cndmask_b32 v193, v193, v209, s[16:17]
    v_cndmask_b32 v194, v194, v210, s[16:17]
    v_cndmask_b32 v195, v195, v211, s[16:17]
    v_bfi_b32 v192, v25, v192, s3
    v_bfi_b32 v193, v25, v193, s3
    v_bfi_b32 v194, v25, v194, s3
    v_bfi_b32 v195, v25, v195, s3
    buffer_store_dwordx4 v[192:195], v24, s[40:43], s57 offen sc1
L_att_noffn:
    s_sub_u32 s60, s33, 1
    s_cmp_gt_u32 s60, 1
    s_cbranch_scc1 L_done
    s_branch L_final
.p2align 12
L_pv0:
    s_mov_b32 s44, s6
    s_mov_b32 s45, s7
    s_mov_b32 s46, 0x2000000
    s_mov_b32 s47, 0x20000
    s_lshl_b32 s35, s34, 18
    v_lshlrev_b32 v8, 2, v2
    v_xor_b32 v8, v8, v3
    v_lshlrev_b32 v8, 4, v8
    v_lshl_add_u32 v4, v2, 10, v8
    v_xor_b32 v5, 16, v4
    v_xor_b32 v6, 32, v4
    v_xor_b32 v7, 48, v4
    s_and_b32 s36, s33, 3
    s_lshl_b32 s36, s36, 15
    s_add_u32 s37, s35, s36
L_pv:
    s_sub_u32 s39, s33, 4
    v_mov_b32 v10, 0
    v_mov_b32 v3, 163584
    v_lshl_add_u32 v9, v1, 2, v3
    s_mov_b64 exec, 15
    ds_write_b32 v9, v10
    s_mov_b64 exec, -1
    s_mov_b32 s52, s10
    s_mov_b32 s53, s11
    s_mov_b32 s54, 0x400000
    s_mov_b32 s55, 0x20000
    s_and_b32 s56, s34, 7
    s_lshr_b32 s60, s34, 5
    s_lshl_b32 s60, s60, 3
    s_or_b32 s56, s56, s60
    s_lshl_b32 s56, s56, 8
    s_bfe_u32 s60, s34, 0x20003
    s_lshl_b32 s60, s60, 2
    s_add_u32 s60, s60, s39
    s_lshl_b32 s60, s60, 18
    s_add_u32 s56, s56, s60
    v_lshrrev_b32 v9, 1, v1
    v_and_b32 v10, 1, v1
    v_lshlrev_b32 v10, 7, v10
    v_lshl_add_u32 v9, v9, 13, v10
    s_waitcnt vmcnt(0)
    buffer_load_dword v26, v9, s[52:55], s56 offen
    s_waitcnt lgkmcnt(0)
    s_barrier
    v_bfe_u32 v10, v1, 2, 2
    v_and_b32 v11, 3, v1
    v_lshrrev_b32 v12, 5, v1
    v_bfe_u32 v13, v1, 4, 1
    v_lshrrev_b32 v14, 1, v11
    v_lshl_or_b32 v14, v13, 1, v14
    v_xor_b32 v14, v14, v12
    v_lshl_or_b32 v14, v10, 2, v14
    v_lshlrev_b32 v14, 4, v14
    v_and_b32 v11, 1, v11
    v_lshl_or_b32 v14, v11, 3, v14
    v_lshl_add_u32 v15, v12, 2, v10
    v_lshl_add_u32 v14, v15, 8, v14
    s_lshl_b32 s38, s39, 13
    v_add_u32 v2, s38, v14
    v_xor_b32 v8, 0, v2
    v_xor_b32 v9, 32, v2
    v_add_u32 v9, 2048, v9
    v_xor_b32 v10, 64, v2
    v_xor_b32 v11, 96, v2
    v_add_u32 v11, 2048, v11
    v_xor_b32 v12, 128, v2
    v_xor_b32 v13, 160, v2
    v_add_u32 v13, 2048, v13
    v_xor_b32 v14, 192, v2
    v_xor_b32 v15, 224, v2
    v_add_u32 v15, 2048, v15
    v_lshlrev_b32 v16, 4, v1
    v_add_u32 v18, s38, v16
    v_add_u32 v16, 139264, v16
    v_lshlrev_b32 v19, 7, v1
    v_mov_b32 v20, 0xfffefffe
    v_and_b32 v28, 31, v1
    v_lshlrev_b32 v17, 2, v28
    v_add_u32 v17, 131072, v17
    v_lshrrev_b32 v29, 5, v1
    v_and_b32 v30, 7, v28
    v_xor_b32 v30, v30, v29
    v_lshlrev_b32 v30, 4, v30
    v_lshl_add_u32 v30, v28, 7, v30
    v_add_u32 v21, s38, v30
    v_lshrrev_b32 v29, 3, v1
    v_and_b32 v30, 7, v1
    v_xor_b32 v30, v30, v29
    v_lshlrev_b32 v30, 4, v30
    v_lshl_add_u32 v22, v29, 17, v30
    v_lshlrev_b32 v23, 4, v28
    s_lshl_b32 s56, s39, 15
    s_lshl_b32 s60, s34, 8
    s_add_u32 s56, s56, s60
    s_add_u32 s56, s56, 2097152
    s_lshl_b32 s57, s34, 9
    s_add_u32 s57, s57, 524288
    s_add_u32 s58, s35, s38
    s_lshl_b32 s59, s39, 11
    s_and_b32 s60, s39, 1
    s_lshl_b32 s60, s60, 5
    v_xor_b32 v4, s60, v4
    v_xor_b32 v5, s60, v5
    s_waitcnt lgkmcnt(0)
    s_add_u32 s32, s32, 1
    s_and_b32 s3, s32, 0xff
    s_bfe_u32 s48, s32, 0x10000
    s_bfe_u32 s60, s32, 0x10001
    s_lshl_b32 s60, s60, 16
    s_or_b32 s48, s48, s60
    s_bfe_u32 s49, s32, 0x10002
    s_bfe_u32 s60, s32, 0x10003
    s_lshl_b32 s60, s60, 16
    s_or_b32 s49, s49, s60
    s_bfe_u32 s50, s32, 0x10004
    s_bfe_u32 s60, s32, 0x10005
    s_lshl_b32 s60, s60, 16
    s_or_b32 s50, s50, s60
    s_bfe_u32 s51, s32, 0x10006
    s_bfe_u32 s60, s32, 0x10007
    s_lshl_b32 s60, s60, 16
    s_or_b32 s51, s51, s60
    s_waitcnt vmcnt(0)
    v_xor_b32 v24, 0, v21
    s_add_u32 s8, s56, 0
    v_xor_b32 v25, 32, v21
    s_add_u32 s9, s56, 1048576
    v_xor_b32 v26, 64, v21
    s_add_u32 s10, s56, 2097152
    v_xor_b32 v27, 96, v21
    s_add_u32 s11, s56, 3145728
    s_branch L_stub3
L_ret3:
    s_branch L_stub6
L_ret6:
    s_branch L_stub4
L_ret4:
    s_lshl_b32 s60, s39, 2
    s_mov_b32 s61, 0
L_cl_25:
    ds_read_b32 v2, v3 offset:12
    s_waitcnt lgkmcnt(0)
    v_bfe_u32 v2, v2, s60, 4
    v_cmp_ne_u32 vcc, 4, v2
    s_cbranch_vccz L_cld_26
    s_add_u32 s61, s61, 1
    s_cmp_gt_u32 s61, s62
    s_cbranch_scc1 L_cld_26
    s_sleep 2
    s_branch L_cl_25
L_cld_26:
    ds_read_b64_tr_b16 v[128:129], v8 offset:0
    ds_read_b64_tr_b16 v[130:131], v9 offset:0
    ds_read_b64_tr_b16 v[132:133], v10 offset:0
    ds_read_b64_tr_b16 v[134:135], v11 offset:0
    ds_read_b64_tr_b16 v[136:137], v12 offset:0
    ds_read_b64_tr_b16 v[138:139], v13 offset:0
    ds_read_b64_tr_b16 v[140:141], v14 offset:0
    ds_read_b64_tr_b16 v[142:143], v15 offset:0
    ds_read_b64_tr_b16 v[144:145], v8 offset:4096
    ds_read_b64_tr_b16 v[146:147], v9 offset:4096
    ds_read_b64_tr_b16 v[148:149], v10 offset:4096
    ds_read_b64_tr_b16 v[150:151], v11 offset:4096
    ds_read_b64_tr_b16 v[152:153], v12 offset:4096
    ds_read_b64_tr_b16 v[154:155], v13 offset:4096
    ds_read_b64_tr_b16 v[156:157], v14 offset:4096
    s_waitcnt lgkmcnt(14)
    ds_read_b64_tr_b16 v[158:159], v15 offset:4096
    s_waitcnt lgkmcnt(14)
    ds_read_b64_tr_b16 v[160:161], v8 offset:32768
    s_waitcnt lgkmcnt(14)
    ds_read_b64_tr_b16 v[162:163], v9 offset:32768
    s_waitcnt lgkmcnt(14)
    ds_read_b64_tr_b16 v[164:165], v10 offset:32768
    s_waitcnt lgkmcnt(14)
    ds_read_b64_tr_b16 v[166:167], v11 offset:32768
    s_waitcnt lgkmcnt(14)
    ds_read_b64_tr_b16 v[168:169], v12 offset:32768
    s_waitcnt lgkmcnt(14)
    ds_read_b64_tr_b16 v[170:171], v13 offset:32768
    s_waitcnt lgkmcnt(14)
    ds_read_b64_tr_b16 v[172:173], v14 offset:32768
    s_waitcnt lgkmcnt(14)
    ds_read_b64_tr_b16 v[174:175], v15 offset:32768
    s_waitcnt lgkmcnt(14)
    ds_read_b64_tr_b16 v[176:177], v8 offset:36864
    s_waitcnt lgkmcnt(14)
    ds_read_b64_tr_b16 v[178:179], v9 offset:36864
    s_waitcnt lgkmcnt(14)
    ds_read_b64_tr_b16 v[180:181], v10 offset:36864
    s_waitcnt lgkmcnt(14)
    ds_read_b64_tr_b16 v[182:183], v11 offset:36864
    s_waitcnt lgkmcnt(14)
    ds_read_b64_tr_b16 v[184:185], v12 offset:36864
    s_waitcnt lgkmcnt(14)
    ds_read_b64_tr_b16 v[186:187], v13 offset:36864
    s_waitcnt lgkmcnt(14)
    ds_read_b64_tr_b16 v[188:189], v14 offset:36864
    s_waitcnt lgkmcnt(14)
    ds_read_b64_tr_b16 v[190:191], v15 offset:36864
    v_xor_b32 v8, 0x10000, v8
    v_xor_b32 v9, 0x10000, v9
    v_xor_b32 v10, 0x10000, v10
    v_xor_b32 v11, 0x10000, v11
    v_xor_b32 v12, 0x10000, v12
    v_xor_b32 v13, 0x10000, v13
    v_xor_b32 v14, 0x10000, v14
    v_xor_b32 v15, 0x10000, v15
    s_waitcnt lgkmcnt(14)
    ds_read_b64_tr_b16 v[192:193], v8 offset:0
    s_waitcnt lgkmcnt(14)
    ds_read_b64_tr_b16 v[194:195], v9 offset:0
    s_waitcnt lgkmcnt(14)
    ds_read_b64_tr_b16 v[196:197], v10 offset:0
    s_waitcnt lgkmcnt(14)
    ds_read_b64_tr_b16 v[198:199], v11 offset:0
    s_waitcnt lgkmcnt(14)
    ds_read_b64_tr_b16 v[200:201], v12 offset:0
    s_waitcnt lgkmcnt(14)
    ds_read_b64_tr_b16 v[202:203], v13 offset:0
    s_waitcnt lgkmcnt(14)
    ds_read_b64_tr_b16 v[204:205], v14 offset:0
    s_waitcnt lgkmcnt(14)
    ds_read_b64_tr_b16 v[206:207], v15 offset:0
    s_waitcnt lgkmcnt(14)
    ds_read_b64_tr_b16 v[208:209], v8 offset:4096
    s_waitcnt lgkmcnt(14)
    ds_read_b64_tr_b16 v[210:211], v9 offset:4096
    s_waitcnt lgkmcnt(14)
    ds_read_b64_tr_b16 v[212:213], v10 offset:4096
    s_waitcnt lgkmcnt(14)
    ds_read_b64_tr_b16 v[214:215], v11 offset:4096
    s_waitcnt lgkmcnt(14)
    ds_read_b64_tr_b16 v[216:217], v12 offset:4096
    s_waitcnt lgkmcnt(14)
    ds_read_b64_tr_b16 v[218:219], v13 offset:4096
    s_waitcnt lgkmcnt(14)
    ds_read_b64_tr_b16 v[220:221], v14 offset:4096
    s_waitcnt lgkmcnt(14)
    ds_read_b64_tr_b16 v[222:223], v15 offset:4096
    s_waitcnt lgkmcnt(14)
    ds_read_b64_tr_b16 v[224:225], v8 offset:32768
    s_waitcnt lgkmcnt(14)
    ds_read_b64_tr_b16 v[226:227], v9 offset:32768
    s_waitcnt lgkmcnt(14)
    ds_read_b64_tr_b16 v[228:229], v10 offset:32768
    s_waitcnt lgkmcnt(14)
    ds_read_b64_tr_b16 v[230:231], v11 offset:32768
    s_waitcnt lgkmcnt(14)
    ds_read_b64_tr_b16 v[232:233], v12 offset:32768
    s_waitcnt lgkmcnt(14)
    ds_read_b64_tr_b16 v[234:235], v13 offset:32768
    s_waitcnt lgkmcnt(14)
    ds_read_b64_tr_b16 v[236:237], v14 offset:32768
    s_waitcnt lgkmcnt(14)
    ds_read_b64_tr_b16 v[238:239], v15 offset:32768
    s_waitcnt lgkmcnt(14)
    ds_read_b64_tr_b16 v[240:241], v8 offset:36864
    s_waitcnt lgkmcnt(14)
    ds_read_b64_tr_b16 v[242:243], v9 offset:36864
    s_waitcnt lgkmcnt(14)
    ds_read_b64_tr_b16 v[244:245], v10 offset:36864
    s_waitcnt lgkmcnt(14)
    ds_read_b64_tr_b16 v[246:247], v11 offset:36864
    s_waitcnt lgkmcnt(14)
    ds_read_b64_tr_b16 v[248:249], v12 offset:36864
    s_waitcnt lgkmcnt(14)
    ds_read_b64_tr_b16 v[250:251], v13 offset:36864
    s_waitcnt lgkmcnt(14)
    ds_read_b64_tr_b16 v[252:253], v14 offset:36864
    s_waitcnt lgkmcnt(14)
    ds_read_b64_tr_b16 v[254:255], v15 offset:36864
    v_xor_b32 v8, 0x10000, v8
    v_xor_b32 v9, 0x10000, v9
    v_xor_b32 v10, 0x10000, v10
    v_xor_b32 v11, 0x10000, v11
    v_xor_b32 v12, 0x10000, v12
    v_xor_b32 v13, 0x10000, v13
    v_xor_b32 v14, 0x10000, v14
    v_xor_b32 v15, 0x10000, v15
    v_mov_b32 v30, 16
    s_mov_b64 exec, 1
    s_waitcnt lgkmcnt(14)
    ds_add_u32 v3, v30 offset:0
    s_mov_b64 exec, -1
    s_mov_b32 s61, 0
L_sm_27:
    ds_read_b32 v2, v3 offset:0
    s_waitcnt lgkmcnt(0)
    v_and_b32 v2, 0xff0, v2
    v_cmp_ne_u32 vcc, 0x480, v2
    s_cbranch_vccz L_smd_28
    s_add_u32 s61, s61, 1
    s_cmp_gt_u32 s61, s62
    s_cbranch_scc1 L_smd_28
    s_sleep 1
    s_branch L_sm_27
L_smd_28:
    s_add_u32 s60, s58, 131072
    s_add_u32 m0, s59, 0
    s_nop 0
    buffer_load_dwordx4 v4, s[44:47], s60 offen nt lds
    s_add_u32 s60, s58, 131328
    s_add_u32 m0, s59, 8192
    s_nop 0
    buffer_load_dwordx4 v4, s[44:47], s60 offen nt lds
    s_add_u32 s60, s58, 131584
    s_add_u32 m0, s59, 16384
    s_nop 0
    buffer_load_dwordx4 v4, s[44:47], s60 offen nt lds
    s_add_u32 s60, s58, 131840
    s_add_u32 m0, s59, 24576
    s_nop 0
    buffer_load_dwordx4 v4, s[44:47], s60 offen nt lds
    s_add_u32 s60, s58, 135168
    s_add_u32 m0, s59, 1024
    s_nop 0
    buffer_load_dwordx4 v5, s[44:47], s60 offen nt lds
    s_add_u32 s60, s58, 135424
    s_add_u32 m0, s59, 9216
    s_nop 0
    buffer_load_dwordx4 v5, s[44:47], s60 offen nt lds
    s_add_u32 s60, s58, 135680
    s_add_u32 m0, s59, 17408
    s_nop 0
    buffer_load_dwordx4 v5, s[44:47], s60 offen nt lds
    s_add_u32 s60, s58, 135936
    s_add_u32 m0, s59, 25600
    s_nop 0
    buffer_load_dwordx4 v5, s[44:47], s60 offen nt lds
    s_mov_b32 s61, 0
L_sp_29:
    ds_read_b32 v2, v3 offset:4
    s_waitcnt lgkmcnt(0)
    v_cmp_ne_u32 vcc, 4, v2
    s_cbranch_vccz L_spd_30
    s_add_u32 s61, s61, 1
    s_cmp_gt_u32 s61, s62
    s_cbranch_scc1 L_spd_30
    s_sleep 1
    s_branch L_sp_29
L_spd_30:
    s_add_u32 s60, s58, 163840
    s_add_u32 m0, s59, 32768
    s_nop 0
    buffer_load_dwordx4 v4, s[44:47], s60 offen lds
    s_add_u32 s60, s58, 167936
    s_add_u32 m0, s59, 33792
    s_nop 0
    buffer_load_dwordx4 v5, s[44:47], s60 offen lds
    s_add_u32 s60, s58, 196608
    s_add_u32 m0, s59, 65536
    s_nop 0
    buffer_load_dwordx4 v4, s[44:47], s60 offen lds
    s_add_u32 s60, s58, 200704
    s_add_u32 m0, s59, 66560
    s_nop 0
    buffer_load_dwordx4 v5, s[44:47], s60 offen lds
    s_add_u32 s60, s58, 229376
    s_add_u32 m0, s59, 98304
    s_nop 0
    buffer_load_dwordx4 v4, s[44:47], s60 offen lds
    s_add_u32 s60, s58, 233472
    s_add_u32 m0, s59, 99328
    s_nop 0
    buffer_load_dwordx4 v5, s[44:47], s60 offen lds
    s_waitcnt vmcnt(13)
    s_add_u32 s60, s58, 164096
    s_add_u32 m0, s59, 40960
    s_nop 0
    buffer_load_dwordx4 v4, s[44:47], s60 offen lds
    s_waitcnt vmcnt(13)
    s_add_u32 s60, s58, 168192
    s_add_u32 m0, s59, 41984
    s_nop 0
    buffer_load_dwordx4 v5, s[44:47], s60 offen lds
    s_waitcnt vmcnt(13)
    s_add_u32 s60, s58, 196864
    s_add_u32 m0, s59, 73728
    s_nop 0
    buffer_load_dwordx4 v4, s[44:47], s60 offen lds
    s_waitcnt vmcnt(13)
    s_add_u32 s60, s58, 200960
    s_add_u32 m0, s59, 74752
    s_nop 0
    buffer_load_dwordx4 v5, s[44:47], s60 offen lds
    s_waitcnt vmcnt(13)
    s_add_u32 s60, s58, 229632
    s_add_u32 m0, s59, 106496
    s_nop 0
    buffer_load_dwordx4 v4, s[44:47], s60 offen lds
    s_waitcnt vmcnt(13)
    s_add_u32 s60, s58, 233728
    s_add_u32 m0, s59, 107520
    s_nop 0
    buffer_load_dwordx4 v5, s[44:47], s60 offen lds
    s_setprio 1
    v_lshl_add_u32 v2, v17, 1, 0
    v_subrev_u32 v2, 131072, v2
    s_barrier
    ds_read_b128 v[32:35], v16 offset:0
    ds_read_b128 v[36:39], v16 offset:1024
    ds_read_b128 v[40:43], v16 offset:2048
    ds_read_b128 v[44:47], v16 offset:3072
    ds_read_b128 v[48:51], v16 offset:4096
    ds_read_b128 v[52:55], v16 offset:5120
    ds_read_b128 v[56:59], v16 offset:6144
    ds_read_b128 v[60:63], v16 offset:7168
    s_waitcnt lgkmcnt(7)
    v_mfma_f32_32x32x16_bf16 v[64:79], v[128:131], v[32:35], 0
    s_add_u32 s60, s58, 164352
    s_add_u32 m0, s59, 49152
    s_nop 0
    buffer_load_dwordx4 v4, s[44:47], s60 offen lds
    v_mfma_f32_32x32x16_bf16 v[80:95], v[132:135], v[32:35], 0
    s_add_u32 s60, s58, 168448
    s_add_u32 m0, s59, 50176
    s_nop 0
    buffer_load_dwordx4 v5, s[44:47], s60 offen lds
    s_waitcnt vmcnt(2)
    s_barrier
    v_mfma_f32_32x32x16_bf16 v[96:111], v[136:139], v[32:35], 0
    s_add_u32 s60, s58, 197120
    s_add_u32 m0, s59, 81920
    s_nop 0
    buffer_load_dwordx4 v4, s[44:47], s60 offen lds
    v_mfma_f32_32x32x16_bf16 v[112:127], v[140:143], v[32:35], 0
    s_add_u32 s60, s58, 201216
    s_add_u32 m0, s59, 82944
    s_nop 0
    buffer_load_dwordx4 v5, s[44:47], s60 offen lds
    s_waitcnt lgkmcnt(6)
    v_mfma_f32_32x32x16_bf16 v[64:79], v[144:147], v[36:39], v[64:79]
    s_add_u32 s60, s58, 229888
    s_add_u32 m0, s59, 114688
    s_nop 0
    buffer_load_dwordx4 v4, s[44:47], s60 offen lds
    v_mfma_f32_32x32x16_bf16 v[80:95], v[148:151], v[36:39], v[80:95]
    s_add_u32 s60, s58, 233984
    s_add_u32 m0, s59, 115712
    s_nop 0
    buffer_load_dwordx4 v5, s[44:47], s60 offen lds
    v_mfma_f32_32x32x16_bf16 v[96:111], v[152:155], v[36:39], v[96:111]
    s_add_u32 s60, s58, 164608
    s_add_u32 m0, s59, 57344
    s_nop 0
    buffer_load_dwordx4 v4, s[44:47], s60 offen lds
    v_mfma_f32_32x32x16_bf16 v[112:127], v[156:159], v[36:39], v[112:127]
    s_add_u32 s60, s58, 168704
    s_add_u32 m0, s59, 58368
    s_nop 0
    buffer_load_dwordx4 v5, s[44:47], s60 offen lds
    s_waitcnt lgkmcnt(5)
    v_mfma_f32_32x32x16_bf16 v[64:79], v[160:163], v[40:43], v[64:79]
    s_add_u32 s60, s58, 197376
    s_add_u32 m0, s59, 90112
    s_nop 0
    buffer_load_dwordx4 v4, s[44:47], s60 offen lds
    v_mfma_f32_32x32x16_bf16 v[80:95], v[164:167], v[40:43], v[80:95]
    s_add_u32 s60, s58, 201472
    s_add_u32 m0, s59, 91136
    s_nop 0
    buffer_load_dwordx4 v5, s[44:47], s60 offen lds
    v_mfma_f32_32x32x16_bf16 v[96:111], v[168:171], v[40:43], v[96:111]
    s_add_u32 s60, s58, 230144
    s_add_u32 m0, s59, 122880
    s_nop 0
    buffer_load_dwordx4 v4, s[44:47], s60 offen lds
    v_mfma_f32_32x32x16_bf16 v[112:127], v[172:175], v[40:43], v[112:127]
    s_add_u32 s60, s58, 234240
    s_add_u32 m0, s59, 123904
    s_nop 0
    buffer_load_dwordx4 v5, s[44:47], s60 offen lds
    s_waitcnt vmcnt(6)
    s_barrier
    s_waitcnt lgkmcnt(4)
    v_mfma_f32_32x32x16_bf16 v[64:79], v[176:179], v[44:47], v[64:79]
    v_mfma_f32_32x32x16_bf16 v[80:95], v[180:183], v[44:47], v[80:95]
    v_mfma_f32_32x32x16_bf16 v[96:111], v[184:187], v[44:47], v[96:111]
    v_mfma_f32_32x32x16_bf16 v[112:127], v[188:191], v[44:47], v[112:127]
    s_waitcnt lgkmcnt(3)
    v_mfma_f32_32x32x16_bf16 v[64:79], v[192:195], v[48:51], v[64:79]
    v_mfma_f32_32x32x16_bf16 v[80:95], v[196:199], v[48:51], v[80:95]
    v_mfma_f32_32x32x16_bf16 v[96:111], v[200:203], v[48:51], v[96:111]
    v_mfma_f32_32x32x16_bf16 v[112:127], v[204:207], v[48:51], v[112:127]
    s_waitcnt lgkmcnt(0)
    s_waitcnt vmcnt(0)
    s_barrier
    s_lshr_b32 s60, s34, 3
    s_lshl_b32 s60, s60, 1
    s_and_b32 s58, s39, 1
    s_add_u32 s60, s60, s58
    s_and_b32 s58, s34, 7
    v_lshrrev_b32 v28, 4, v1
    v_lshl_add_u32 v28, v28, 3, s58
    v_and_b32 v29, 15, v1
    s_cmp_gt_u32 s39, 1
    s_cbranch_scc1 L_xf_31
    s_mov_b32 s52, s18
    s_mov_b32 s53, s19
    s_mov_b32 s54, 0x1c0000
    s_mov_b32 s55, 0x20000
    s_mul_i32 s60, s60, 57344
    s_movk_i32 s58, 3584
    v_mul_u32_u24 v29, s58, v29
    v_lshl_add_u32 v29, v28, 7, v29
    v_cmp_gt_u32 vcc, 28, v28
    s_nop 1
    v_mov_b32 v30, 0x7ffffff0
    v_cndmask_b32 v29, v30, v29, vcc
    buffer_load_dword v19, v29, s[52:55], s60 offen
    s_branch L_xf_32
L_xf_31:
    s_mov_b32 s52, s22
    s_mov_b32 s53, s23
    s_mov_b32 s54, 0x1c0000
    s_mov_b32 s55, 0x20000
    s_lshl_b32 s60, s60, 11
    v_lshlrev_b32 v29, 7, v29
    v_lshl_add_u32 v29, v28, 16, v29
    buffer_load_dword v19, v29, s[52:55], s60 offen
L_xf_32:
    ds_read_b64_tr_b16 v[128:129], v8 offset:0
    ds_read_b64_tr_b16 v[130:131], v9 offset:0
    ds_read_b64_tr_b16 v[132:133], v10 offset:0
    ds_read_b64_tr_b16 v[134:135], v11 offset:0
    ds_read_b64_tr_b16 v[136:137], v12 offset:0
    v_mfma_f32_32x32x16_bf16 v[64:79], v[208:211], v[52:55], v[64:79]
    ds_read_b64_tr_b16 v[138:139], v13 offset:0
    ds_read_b64_tr_b16 v[140:141], v14 offset:0
    ds_read_b64_tr_b16 v[142:143], v15 offset:0
    ds_read_b64_tr_b16 v[144:145], v8 offset:4096
    ds_read_b64_tr_b16 v[146:147], v9 offset:4096
    v_mfma_f32_32x32x16_bf16 v[80:95], v[212:215], v[52:55], v[80:95]
    ds_read_b64_tr_b16 v[148:149], v10 offset:4096
    ds_read_b64_tr_b16 v[150:151], v11 offset:4096
    ds_read_b64_tr_b16 v[152:153], v12 offset:4096
    ds_read_b64_tr_b16 v[154:155], v13 offset:4096
    ds_read_b64_tr_b16 v[156:157], v14 offset:4096
    v_mfma_f32_32x32x16_bf16 v[96:111], v[216:219], v[52:55], v[96:111]
    s_waitcnt lgkmcnt(14)
    ds_read_b64_tr_b16 v[158:159], v15 offset:4096
    s_waitcnt lgkmcnt(14)
    ds_read_b64_tr_b16 v[160:161], v8 offset:32768
    s_waitcnt lgkmcnt(14)
    ds_read_b64_tr_b16 v[162:163], v9 offset:32768
    s_waitcnt lgkmcnt(14)
    ds_read_b64_tr_b16 v[164:165], v10 offset:32768
    s_waitcnt lgkmcnt(14)
    ds_read_b64_tr_b16 v[166:167], v11 offset:32768
    v_mfma_f32_32x32x16_bf16 v[112:127], v[220:223], v[52:55], v[112:127]
    s_waitcnt lgkmcnt(14)
    ds_read_b64_tr_b16 v[168:169], v12 offset:32768
    s_waitcnt lgkmcnt(14)
    ds_read_b64_tr_b16 v[170:171], v13 offset:32768
    s_waitcnt lgkmcnt(14)
    ds_read_b64_tr_b16 v[172:173], v14 offset:32768
    s_waitcnt lgkmcnt(14)
    ds_read_b64_tr_b16 v[174:175], v15 offset:32768
    s_waitcnt lgkmcnt(14)
    ds_read_b64_tr_b16 v[176:177], v8 offset:36864
    v_mfma_f32_32x32x16_bf16 v[64:79], v[224:227], v[56:59], v[64:79]
    s_waitcnt lgkmcnt(14)
    ds_read_b64_tr_b16 v[178:179], v9 offset:36864
    s_waitcnt lgkmcnt(14)
    ds_read_b64_tr_b16 v[180:181], v10 offset:36864
    s_waitcnt lgkmcnt(14)
    ds_read_b64_tr_b16 v[182:183], v11 offset:36864
    s_waitcnt lgkmcnt(14)
    ds_read_b64_tr_b16 v[184:185], v12 offset:36864
    s_waitcnt lgkmcnt(14)
    ds_read_b64_tr_b16 v[186:187], v13 offset:36864
    v_mfma_f32_32x32x16_bf16 v[80:95], v[228:231], v[56:59], v[80:95]
    s_waitcnt lgkmcnt(14)
    ds_read_b64_tr_b16 v[188:189], v14 offset:36864
    s_waitcnt lgkmcnt(14)
    ds_read_b64_tr_b16 v[190:191], v15 offset:36864
    v_xor_b32 v8, 0x10000, v8
    v_xor_b32 v9, 0x10000, v9
    v_xor_b32 v10, 0x10000, v10
    v_xor_b32 v11, 0x10000, v11
    v_xor_b32 v12, 0x10000, v12
    v_xor_b32 v13, 0x10000, v13
    v_xor_b32 v14, 0x10000, v14
    v_xor_b32 v15, 0x10000, v15
    s_waitcnt lgkmcnt(14)
    ds_read_b64_tr_b16 v[192:193], v8 offset:0
    s_waitcnt lgkmcnt(14)
    ds_read_b64_tr_b16 v[194:195], v9 offset:0
    s_waitcnt lgkmcnt(14)
    ds_read_b64_tr_b16 v[196:197], v10 offset:0
    v_mfma_f32_32x32x16_bf16 v[96:111], v[232:235], v[56:59], v[96:111]
    s_waitcnt lgkmcnt(14)
    ds_read_b64_tr_b16 v[198:199], v11 offset:0
    s_waitcnt lgkmcnt(14)
    ds_read_b64_tr_b16 v[200:201], v12 offset:0
    s_waitcnt lgkmcnt(14)
    ds_read_b64_tr_b16 v[202:203], v13 offset:0
    s_waitcnt lgkmcnt(14)
    ds_read_b64_tr_b16 v[204:205], v14 offset:0
    s_waitcnt lgkmcnt(14)
    ds_read_b64_tr_b16 v[206:207], v15 offset:0
    v_mfma_f32_32x32x16_bf16 v[112:127], v[236:239], v[56:59], v[112:127]
    s_waitcnt lgkmcnt(14)
    ds_read_b64_tr_b16 v[208:209], v8 offset:4096
    s_waitcnt lgkmcnt(14)
    ds_read_b64_tr_b16 v[210:211], v9 offset:4096
    s_waitcnt lgkmcnt(14)
    ds_read_b64_tr_b16 v[212:213], v10 offset:4096
    s_waitcnt lgkmcnt(14)
    ds_read_b64_tr_b16 v[214:215], v11 offset:4096
    s_waitcnt lgkmcnt(14)
    ds_read_b64_tr_b16 v[216:217], v12 offset:4096
    v_mfma_f32_32x32x16_bf16 v[64:79], v[240:243], v[60:63], v[64:79]
    s_waitcnt lgkmcnt(14)
    ds_read_b64_tr_b16 v[218:219], v13 offset:4096
    s_waitcnt lgkmcnt(14)
    ds_read_b64_tr_b16 v[220:221], v14 offset:4096
    s_waitcnt lgkmcnt(14)
    ds_read_b64_tr_b16 v[222:223], v15 offset:4096
    s_waitcnt lgkmcnt(14)
    ds_read_b64_tr_b16 v[224:225], v8 offset:32768
    s_waitcnt lgkmcnt(14)
    ds_read_b64_tr_b16 v[226:227], v9 offset:32768
    v_mfma_f32_32x32x16_bf16 v[80:95], v[244:247], v[60:63], v[80:95]
    s_waitcnt lgkmcnt(14)
    ds_read_b64_tr_b16 v[228:229], v10 offset:32768
    s_waitcnt lgkmcnt(14)
    ds_read_b64_tr_b16 v[230:231], v11 offset:32768
    s_waitcnt lgkmcnt(14)
    ds_read_b64_tr_b16 v[232:233], v12 offset:32768
    s_waitcnt lgkmcnt(14)
    ds_read_b64_tr_b16 v[234:235], v13 offset:32768
    s_waitcnt lgkmcnt(14)
    ds_read_b64_tr_b16 v[236:237], v14 offset:32768
    v_mfma_f32_32x32x16_bf16 v[96:111], v[248:251], v[60:63], v[96:111]
    s_waitcnt lgkmcnt(14)
    ds_read_b64_tr_b16 v[238:239], v15 offset:32768
    s_waitcnt lgkmcnt(14)
    ds_read_b64_tr_b16 v[240:241], v8 offset:36864
    s_waitcnt lgkmcnt(14)
    ds_read_b64_tr_b16 v[242:243], v9 offset:36864
    s_waitcnt lgkmcnt(14)
    ds_read_b64_tr_b16 v[244:245], v10 offset:36864
    s_waitcnt lgkmcnt(14)
    ds_read_b64_tr_b16 v[246:247], v11 offset:36864
    v_mfma_f32_32x32x16_bf16 v[112:127], v[252:255], v[60:63], v[112:127]
    s_waitcnt lgkmcnt(14)
    ds_read_b64_tr_b16 v[248:249], v12 offset:36864
    s_waitcnt lgkmcnt(14)
    ds_read_b64_tr_b16 v[250:251], v13 offset:36864
    s_waitcnt lgkmcnt(14)
    ds_read_b64_tr_b16 v[252:253], v14 offset:36864
    s_waitcnt lgkmcnt(14)
    ds_read_b64_tr_b16 v[254:255], v15 offset:36864
    s_branch L_pg6
.p2align 12
L_stub6:
    s_branch L_ret6
L_pg6:
    s_barrier
    s_waitcnt lgkmcnt(14)
    ds_read_b64 v[28:29], v2 offset:1024
    s_waitcnt lgkmcnt(14)
    ds_read_b128 v[32:35], v16 offset:0
    s_waitcnt lgkmcnt(14)
    ds_read_b128 v[36:39], v16 offset:1024
    s_waitcnt lgkmcnt(14)
    ds_read_b128 v[40:43], v16 offset:2048
    s_waitcnt lgkmcnt(14)
    ds_read_b128 v[44:47], v16 offset:3072
    s_waitcnt lgkmcnt(14)
    ds_read_b128 v[48:51], v16 offset:4096
    s_waitcnt lgkmcnt(14)
    ds_read_b128 v[52:55], v16 offset:5120
    s_waitcnt lgkmcnt(14)
    ds_read_b128 v[56:59], v16 offset:6144
    s_waitcnt lgkmcnt(14)
    ds_read_b128 v[60:63], v16 offset:7168
    s_waitcnt lgkmcnt(8)
    v_cmp_neq_f32 vcc, 1.0, v28
    s_cbranch_vccnz L_pv_rescale
L_pv_scaled:
    s_waitcnt lgkmcnt(7)
    v_mfma_f32_32x32x16_bf16 v[64:79], v[128:131], v[32:35], v[64:79]
    s_waitcnt lgkmcnt(6)
    v_mfma_f32_32x32x16_bf16 v[64:79], v[144:147], v[36:39], v[64:79]
    s_waitcnt lgkmcnt(5)
    v_mfma_f32_32x32x16_bf16 v[64:79], v[160:163], v[40:43], v[64:79]
    s_waitcnt lgkmcnt(4)
    v_mfma_f32_32x32x16_bf16 v[64:79], v[176:179], v[44:47], v[64:79]
    s_waitcnt lgkmcnt(3)
    v_mfma_f32_32x32x16_bf16 v[64:79], v[192:195], v[48:51], v[64:79]
    s_waitcnt lgkmcnt(2)
    v_mfma_f32_32x32x16_bf16 v[64:79], v[208:211], v[52:55], v[64:79]
    s_waitcnt lgkmcnt(1)
    v_mfma_f32_32x32x16_bf16 v[64:79], v[224:227], v[56:59], v[64:79]
    s_waitcnt lgkmcnt(0)
    v_mfma_f32_32x32x16_bf16 v[64:79], v[240:243], v[60:63], v[64:79]
    v_mfma_f32_32x32x16_bf16 v[80:95], v[132:135], v[32:35], v[80:95]
    s_barrier
    s_nop 3
    v_mfma_f32_32x32x16_bf16 v[80:95], v[148:151], v[36:39], v[80:95]
    s_nop 3
    v_mfma_f32_32x32x16_bf16 v[80:95], v[164:167], v[40:43], v[80:95]
    v_cvt_pk_bf16_f32 v64, v64, v65
    v_cvt_pk_bf16_f32 v65, v66, v67
    v_cvt_pk_bf16_f32 v66, v68, v69
    v_mfma_f32_32x32x16_bf16 v[80:95], v[180:183], v[44:47], v[80:95]
    v_cvt_pk_bf16_f32 v67, v70, v71
    v_bfi_b32 v64, v20, v64, s48
    v_bfi_b32 v65, v20, v65, s49
    v_mfma_f32_32x32x16_bf16 v[80:95], v[196:199], v[48:51], v[80:95]
    v_bfi_b32 v66, v20, v66, s50
    v_bfi_b32 v67, v20, v67, s51
    ds_write_b128 v24, v[64:67] offset:0
    v_mfma_f32_32x32x16_bf16 v[80:95], v[212:215], v[52:55], v[80:95]
    v_cvt_pk_bf16_f32 v72, v72, v73
    v_cvt_pk_bf16_f32 v73, v74, v75
    v_cvt_pk_bf16_f32 v74, v76, v77
    v_mfma_f32_32x32x16_bf16 v[80:95], v[228:231], v[56:59], v[80:95]
    v_cvt_pk_bf16_f32 v75, v78, v79
    v_bfi_b32 v72, v20, v72, s48
    v_bfi_b32 v73, v20, v73, s49
    v_mfma_f32_32x32x16_bf16 v[80:95], v[244:247], v[60:63], v[80:95]
    v_bfi_b32 v74, v20, v74, s50
    v_bfi_b32 v75, v20, v75, s51
    ds_write_b128 v25, v[72:75] offset:0
    v_mfma_f32_32x32x16_bf16 v[96:111], v[136:139], v[32:35], v[96:111]
    s_nop 4
    v_mfma_f32_32x32x16_bf16 v[96:111], v[152:155], v[36:39], v[96:111]
    s_nop 3
    v_mfma_f32_32x32x16_bf16 v[96:111], v[168:171], v[40:43], v[96:111]
    v_cvt_pk_bf16_f32 v80, v80, v81
    v_cvt_pk_bf16_f32 v81, v82, v83
    v_cvt_pk_bf16_f32 v82, v84, v85
    v_cvt_pk_bf16_f32 v83, v86, v87
    v_mfma_f32_32x32x16_bf16 v[96:111], v[184:187], v[44:47], v[96:111]
    v_bfi_b32 v80, v20, v80, s48
    v_bfi_b32 v81, v20, v81, s49
    v_bfi_b32 v82, v20, v82, s50
    v_bfi_b32 v83, v20, v83, s51
    v_mfma_f32_32x32x16_bf16 v[96:111], v[200:203], v[48:51], v[96:111]
    ds_write_b128 v26, v[80:83] offset:0
    v_cvt_pk_bf16_f32 v88, v88, v89
    v_cvt_pk_bf16_f32 v89, v90, v91
    v_cvt_pk_bf16_f32 v90, v92, v93
    v_mfma_f32_32x32x16_bf16 v[96:111], v[216:219], v[52:55], v[96:111]
    v_cvt_pk_bf16_f32 v91, v94, v95
    v_bfi_b32 v88, v20, v88, s48
    v_bfi_b32 v89, v20, v89, s49
    v_bfi_b32 v90, v20, v90, s50
    v_mfma_f32_32x32x16_bf16 v[96:111], v[232:235], v[56:59], v[96:111]
    v_bfi_b32 v91, v20, v91, s51
    ds_write_b128 v27, v[88:91] offset:0
    ds_read_b128 v[68:71], v18 offset:0
    v_mfma_f32_32x32x16_bf16 v[96:111], v[248:251], v[60:63], v[96:111]
    ds_read_b128 v[76:79], v18 offset:1024
    ds_read_b128 v[84:87], v18 offset:2048
    ds_read_b128 v[92:95], v18 offset:3072
    v_mfma_f32_32x32x16_bf16 v[112:127], v[140:143], v[32:35], v[112:127]
    s_waitcnt lgkmcnt(3)
    buffer_store_dwordx4 v[68:71], v22, s[40:43], s8 offen offset:0 sc1
    s_waitcnt lgkmcnt(2)
    buffer_store_dwordx4 v[76:79], v22, s[40:43], s9 offen offset:0 sc1
    s_nop 0
    v_mfma_f32_32x32x16_bf16 v[112:127], v[156:159], v[36:39], v[112:127]
    s_waitcnt lgkmcnt(1)
    buffer_store_dwordx4 v[84:87], v22, s[40:43], s10 offen offset:0 sc1
    s_waitcnt lgkmcnt(0)
    buffer_store_dwordx4 v[92:95], v22, s[40:43], s11 offen offset:0 sc1
    v_mfma_f32_32x32x16_bf16 v[112:127], v[172:175], v[40:43], v[112:127]
    v_cvt_pk_bf16_f32 v96, v96, v97
    v_cvt_pk_bf16_f32 v97, v98, v99
    v_cvt_pk_bf16_f32 v98, v100, v101
    v_mfma_f32_32x32x16_bf16 v[112:127], v[188:191], v[44:47], v[112:127]
    v_cvt_pk_bf16_f32 v99, v102, v103
    v_bfi_b32 v96, v20, v96, s48
    v_bfi_b32 v97, v20, v97, s49
    v_mfma_f32_32x32x16_bf16 v[112:127], v[204:207], v[48:51], v[112:127]
    v_bfi_b32 v98, v20, v98, s50
    v_bfi_b32 v99, v20, v99, s51
    ds_write_b128 v24, v[96:99] offset:4096
    v_mfma_f32_32x32x16_bf16 v[112:127], v[220:223], v[52:55], v[112:127]
    v_cvt_pk_bf16_f32 v104, v104, v105
    v_cvt_pk_bf16_f32 v105, v106, v107
    v_cvt_pk_bf16_f32 v106, v108, v109
    v_mfma_f32_32x32x16_bf16 v[112:127], v[236:239], v[56:59], v[112:127]
    v_cvt_pk_bf16_f32 v107, v110, v111
    v_bfi_b32 v104, v20, v104, s48
    v_bfi_b32 v105, v20, v105, s49
    v_mfma_f32_32x32x16_bf16 v[112:127], v[252:255], v[60:63], v[112:127]
    v_bfi_b32 v106, v20, v106, s50
    v_bfi_b32 v107, v20, v107, s51
    ds_write_b128 v25, v[104:107] offset:4096
    s_nop 7
    s_nop 3
    v_cvt_pk_bf16_f32 v112, v112, v113
    v_cvt_pk_bf16_f32 v113, v114, v115
    v_cvt_pk_bf16_f32 v114, v116, v117
    v_cvt_pk_bf16_f32 v115, v118, v119
    v_bfi_b32 v112, v20, v112, s48
    v_bfi_b32 v113, v20, v113, s49
    v_bfi_b32 v114, v20, v114, s50
    v_bfi_b32 v115, v20, v115, s51
    ds_write_b128 v26, v[112:115] offset:4096
    v_cvt_pk_bf16_f32 v120, v120, v121
    v_cvt_pk_bf16_f32 v121, v122, v123
    v_cvt_pk_bf16_f32 v122, v124, v125
    v_cvt_pk_bf16_f32 v123, v126, v127
    v_bfi_b32 v120, v20, v120, s48
    v_bfi_b32 v121, v20, v121, s49
    v_bfi_b32 v122, v20, v122, s50
    v_bfi_b32 v123, v20, v123, s51
    ds_write_b128 v27, v[120:123] offset:4096
    ds_read_b128 v[100:103], v18 offset:4096
    ds_read_b128 v[108:111], v18 offset:5120
    ds_read_b128 v[116:119], v18 offset:6144
    ds_read_b128 v[124:127], v18 offset:7168
    s_waitcnt lgkmcnt(3)
    buffer_store_dwordx4 v[100:103], v22, s[40:43], s8 offen offset:128 sc1
    s_waitcnt lgkmcnt(2)
    buffer_store_dwordx4 v[108:111], v22, s[40:43], s9 offen offset:128 sc1
    s_waitcnt lgkmcnt(1)
    buffer_store_dwordx4 v[116:119], v22, s[40:43], s10 offen offset:128 sc1
    s_waitcnt lgkmcnt(0)
    buffer_store_dwordx4 v[124:127], v22, s[40:43], s11 offen offset:128 sc1
    s_branch L_done
L_final:
    s_and_b32 s36, s34, 63
    s_lshr_b32 s37, s34, 6
    s_lshl_b32 s38, s36, 4
    s_lshl_b32 s39, s37, 10
    s_add_u32 s39, s39, s38
    v_and_b32 v2, 1, v1
    v_lshrrev_b32 v3, 4, v1
    v_lshl_add_u32 v43, v2, 2, v3
    v_lshlrev_b32 v43, 1, v43
    v_lshlrev_b32 v44, 3, v1
    v_add_u32 v44, 102400, v44
    v_lshrrev_b32 v40, 1, v1
    v_lshlrev_b32 v40, 12, v40
    v_lshl_add_u32 v40, v2, 4, v40
    s_lshl_b32 s60, s37, 11
    s_lshl_b32 s63, s36, 5
    s_add_u32 s63, s63, s60
    v_lshlrev_b32 v42, 7, v1
    s_cmp_eq_u32 s33, 1
    s_cbranch_scc1 L_fin_sum
    s_mov_b32 s52, s24
    s_mov_b32 s53, s25
    s_mov_b32 s54, 0x400
    s_mov_b32 s55, 0x20000
    buffer_load_ushort v8, v43, s[52:55], s38 offen
    v_mul_u32_u24 v41, 7, v1
    s_and_b32 s60, s34, 3
    v_add_u32 v41, s60, v41
    v_lshlrev_b32 v41, 7, v41
    s_mov_b32 s60, 360448
    s_mov_b32 s61, 0
    s_mov_b64 exec, 0xff
L_y2_33:
    buffer_load_dword v16, v41, s[40:43], s60 offen sc1
    s_waitcnt vmcnt(0)
    v_cmp_ne_u32 vcc, s32, v16
    s_cbranch_vccz L_y2d_34
    s_add_u32 s61, s61, 1
    s_cmp_gt_u32 s61, s62
    s_cbranch_scc1 L_y2d_34
    s_sleep 4
    s_branch L_y2_33
L_y2d_34:
    s_mov_b64 exec, -1
    s_mov_b32 s61, 0
    s_add_u32 s60, s63, 1572864
    s_add_u32 s36, s60, 131072
    v_lshlrev_b32 v8, 16, v8
L_yp_35:
    v_mov_b32 v20, s3
    v_mov_b32 v21, s3
    v_mov_b32 v22, s3
    v_mov_b32 v23, s3
    buffer_load_dwordx4 v[16:19], v40, s[40:43], s60 offen sc1
    s_mov_b32 exec_hi, 0xffff
    buffer_load_dwordx4 v[20:23], v40, s[40:43], s36 offen sc1
    s_mov_b64 exec, -1
    s_waitcnt vmcnt(0)
    v_xor_b32 v16, s3, v16
    v_xor_b32 v17, s3, v17
    v_xor_b32 v18, s3, v18
    v_xor_b32 v19, s3, v19
    v_xor_b32 v20, s3, v20
    v_xor_b32 v21, s3, v21
    v_xor_b32 v22, s3, v22
    v_xor_b32 v23, s3, v23
    v_or_b32 v41, v16, v17
    v_or3_b32 v41, v41, v18, v19
    v_or3_b32 v41, v41, v20, v21
    v_or3_b32 v41, v41, v22, v23
    v_and_b32 v41, 0xff, v41
    v_cmp_ne_u32 vcc, 0, v41
    s_cbranch_vccz L_ypd_36
    s_add_u32 s61, s61, 1
    s_cmp_gt_u32 s61, s62
    s_cbranch_scc1 L_ypd_36
    s_sleep 1
    s_branch L_yp_35
L_ypd_36:
    v_pk_add_f32 v[16:17], v[16:17], v[20:21]
    v_pk_add_f32 v[18:19], v[18:19], v[22:23]
    s_nop 1
    v_permlane32_swap_b32 v16, v18
    v_permlane32_swap_b32 v17, v19
    v_add_f32 v16, v16, v18
    v_add_f32 v17, v17, v19
    s_nop 1
    v_permlane16_swap_b32 v16, v17
    v_add_f32 v16, v16, v17
    s_nop 1
    v_add_f32_dpp v16, v16, v16 quad_perm:[2,3,0,1] row_mask:0xf bank_mask:0xf
    s_nop 1
    v_add_f32_dpp v16, v16, v16 row_ror:4 row_mask:0xf bank_mask:0xf
    s_nop 1
    v_add_f32_dpp v16, v16, v16 row_ror:8 row_mask:0xf bank_mask:0xf
    v_cvt_pk_bf16_f32 v16, v16, v16
    v_lshlrev_b32 v16, 16, v16
    v_add_f32 v16, v16, v8
    v_cvt_pk_bf16_f32 v16, v16, v16
    v_lshlrev_b32 v16, 16, v16
    v_mul_f32 v17, 0xbfb8aa3b, v16
    v_exp_f32 v17, v17
    s_nop 0
    v_add_f32 v17, 1.0, v17
    v_rcp_f32 v17, v17
    s_nop 0
    v_mul_f32 v16, v16, v17
    v_cvt_pk_bf16_f32 v16, v16, v16
    v_lshlrev_b32 v16, 16, v16
    v_mov_b32 v17, s32
    ds_write_b64 v44, v[16:17]
    s_branch L_done
L_fin_sum:
    s_mov_b32 s48, s4
    s_mov_b32 s49, s5
    s_mov_b32 s50, 0x800
    s_mov_b32 s51, 0x20000
    s_mov_b32 s56, s26
    s_mov_b32 s57, s27
    s_mov_b32 s58, 0x800
    s_mov_b32 s59, 0x20000
    buffer_load_ushort v8, v43, s[48:51], s39 offen
    s_add_u32 s52, s63, 1048576
    s_add_u32 s53, s63, 1179648
    s_add_u32 s54, s63, 1310720
    s_add_u32 s55, s63, 1441792
    v_mul_u32_u24 v41, 17, v1
    v_add_u32 v41, s34, v41
    v_and_b32 v41, 127, v41
    v_lshlrev_b32 v41, 7, v41
    s_mov_b32 s60, 344064
    s_mov_b32 s61, 0
    s_mov_b64 exec, 0xff
L_s1_37:
    buffer_load_dword v16, v41, s[40:43], s60 offen sc1
    s_waitcnt vmcnt(0)
    v_cmp_eq_u32 vcc, s32, v16
    s_bcnt1_i32_b64 s35, vcc
    s_cmp_ge_u32 s35, 8
    s_cbranch_scc1 L_s1d_38
    s_add_u32 s61, s61, 1
    s_cmp_gt_u32 s61, s62
    s_cbranch_scc1 L_s1d_38
    s_sleep 4
    s_branch L_s1_37
L_s1d_38:
    s_mov_b64 exec, -1
    v_lshlrev_b32 v8, 16, v8
    s_mov_b32 s61, 0
L_sp_39:
    buffer_load_dwordx4 v[16:19], v40, s[40:43], s52 offen sc1
    buffer_load_dwordx4 v[20:23], v40, s[40:43], s53 offen sc1
    buffer_load_dwordx4 v[24:27], v40, s[40:43], s54 offen sc1
    buffer_load_dwordx4 v[28:31], v40, s[40:43], s55 offen sc1
    ds_read_b64 v[10:11], v44
    s_waitcnt vmcnt(0)
    v_xor_b32 v16, s3, v16
    v_xor_b32 v17, s3, v17
    v_xor_b32 v18, s3, v18
    v_xor_b32 v19, s3, v19
    v_xor_b32 v20, s3, v20
    v_xor_b32 v21, s3, v21
    v_xor_b32 v22, s3, v22
    v_xor_b32 v23, s3, v23
    v_xor_b32 v24, s3, v24
    v_xor_b32 v25, s3, v25
    v_xor_b32 v26, s3, v26
    v_xor_b32 v27, s3, v27
    v_xor_b32 v28, s3, v28
    v_xor_b32 v29, s3, v29
    v_xor_b32 v30, s3, v30
    v_xor_b32 v31, s3, v31
    v_or_b32 v41, v16, v17
    v_or3_b32 v41, v41, v18, v19
    v_or3_b32 v41, v41, v20, v21
    v_or3_b32 v41, v41, v22, v23
    v_or3_b32 v41, v41, v24, v25
    v_or3_b32 v41, v41, v26, v27
    v_or3_b32 v41, v41, v28, v29
    v_or3_b32 v41, v41, v30, v31
    v_and_b32 v41, 0xff, v41
    v_cmp_ne_u32 vcc, 0, v41
    s_cbranch_vccz L_spd_40
    s_add_u32 s61, s61, 1
    s_cmp_gt_u32 s61, s62
    s_cbranch_scc1 L_spd_40
    s_branch L_sp_39
L_spd_40:
    v_pk_add_f32 v[16:17], v[16:17], v[20:21]
    v_pk_add_f32 v[24:25], v[24:25], v[28:29]
    v_pk_add_f32 v[18:19], v[18:19], v[22:23]
    v_pk_add_f32 v[26:27], v[26:27], v[30:31]
    v_pk_add_f32 v[16:17], v[16:17], v[24:25]
    v_pk_add_f32 v[18:19], v[18:19], v[26:27]
    s_nop 1
    v_permlane32_swap_b32 v16, v18
    v_permlane32_swap_b32 v17, v19
    v_add_f32 v16, v16, v18
    v_add_f32 v17, v17, v19
    s_nop 1
    v_permlane16_swap_b32 v16, v17
    v_add_f32 v16, v16, v17
    s_nop 1
    v_add_f32_dpp v16, v16, v16 quad_perm:[2,3,0,1] row_mask:0xf bank_mask:0xf
    s_nop 1
    v_add_f32_dpp v16, v16, v16 row_ror:4 row_mask:0xf bank_mask:0xf
    s_nop 1
    v_add_f32_dpp v16, v16, v16 row_ror:8 row_mask:0xf bank_mask:0xf
    v_cvt_pk_bf16_f32 v16, v16, v16
    v_lshlrev_b32 v16, 16, v16
    s_mov_b32 s61, 0
L_ga_41:
    s_waitcnt lgkmcnt(0)
    v_cmp_ne_u32 vcc, s32, v11
    s_cbranch_vccz L_gad_42
    ds_read_b64 v[10:11], v44
    s_add_u32 s61, s61, 1
    s_cmp_gt_u32 s61, s62
    s_cbranch_scc1 L_gad_42
    s_branch L_ga_41
L_gad_42:
    s_waitcnt lgkmcnt(0)
    v_mul_f32 v16, v16, v10
    v_cvt_pk_bf16_f32 v16, v16, v16
    v_lshlrev_b32 v16, 16, v16
    v_add_f32 v16, v16, v8
    v_cvt_pk_bf16_f32 v16, v16, v16
    s_mov_b32 exec_lo, 0x00030003
    s_mov_b32 exec_hi, 0x00030003
    buffer_store_short v16, v43, s[56:59], s39 offen sc1
    s_branch L_done
L_qg_11:
    s_add_u32 s61, s61, 1
    s_cmp_gt_u32 s61, s62
    s_cbranch_scc1 L_qgd_12
    s_sleep 2
    buffer_load_dwordx4 v[72:75], v115, s[40:43], s63 offen offset:0 sc1
    buffer_load_dwordx4 v[76:79], v115, s[40:43], s63 offen offset:1024 sc1
    buffer_load_dwordx4 v[80:83], v115, s[40:43], s63 offen offset:2048 sc1
    buffer_load_dwordx4 v[84:87], v115, s[40:43], s63 offen offset:3072 sc1
    buffer_load_dwordx4 v[88:91], v115, s[40:43], s59 offen offset:0 sc1
    buffer_load_dwordx4 v[92:95], v115, s[40:43], s59 offen offset:1024 sc1
    buffer_load_dwordx4 v[96:99], v115, s[40:43], s59 offen offset:2048 sc1
    buffer_load_dwordx4 v[100:103], v115, s[40:43], s59 offen offset:3072 sc1
    v_mov_b32 v124, s52
    v_mov_b32 v125, s53
    v_mov_b32 v126, s54
    v_mov_b32 v127, s55
    s_mov_b32 exec_lo, 0
    s_mov_b32 exec_hi, 0xf0000000
    buffer_load_dwordx4 v[124:127], v115, s[40:43], s56 offen sc1
    s_mov_b64 exec, -1
    s_branch L_qf_7
L_pk_15:
    s_mov_b32 s61, 0
L_pkt_17:
    ds_read_b32 v111, v104 offset:8
    s_waitcnt lgkmcnt(0)
    v_and_b32 v111, 15, v111
    v_cmp_ne_u32 vcc, 4, v111
    s_cbranch_vccz L_pkb_16
    s_add_u32 s61, s61, 1
    s_cmp_gt_u32 s61, s62
    s_cbranch_scc1 L_pkb_16
    s_branch L_pkt_17
L_pv_rescale:
    v_mul_f32 v64, v64, v28
    v_mul_f32 v65, v65, v28
    v_mul_f32 v66, v66, v28
    v_mul_f32 v67, v67, v28
    v_mul_f32 v68, v68, v28
    v_mul_f32 v69, v69, v28
    v_mul_f32 v70, v70, v28
    v_mul_f32 v71, v71, v28
    v_mul_f32 v72, v72, v28
    v_mul_f32 v73, v73, v28
    v_mul_f32 v74, v74, v28
    v_mul_f32 v75, v75, v28
    v_mul_f32 v76, v76, v28
    v_mul_f32 v77, v77, v28
    v_mul_f32 v78, v78, v28
    v_mul_f32 v79, v79, v28
    v_mul_f32 v80, v80, v28
    v_mul_f32 v81, v81, v28
    v_mul_f32 v82, v82, v28
    v_mul_f32 v83, v83, v28
    v_mul_f32 v84, v84, v28
    v_mul_f32 v85, v85, v28
    v_mul_f32 v86, v86, v28
    v_mul_f32 v87, v87, v28
    v_mul_f32 v88, v88, v28
    v_mul_f32 v89, v89, v28
    v_mul_f32 v90, v90, v28
    v_mul_f32 v91, v91, v28
    v_mul_f32 v92, v92, v28
    v_mul_f32 v93, v93, v28
    v_mul_f32 v94, v94, v28
    v_mul_f32 v95, v95, v28
    v_mul_f32 v96, v96, v28
    v_mul_f32 v97, v97, v28
    v_mul_f32 v98, v98, v28
    v_mul_f32 v99, v99, v28
    v_mul_f32 v100, v100, v28
    v_mul_f32 v101, v101, v28
    v_mul_f32 v102, v102, v28
    v_mul_f32 v103, v103, v28
    v_mul_f32 v104, v104, v28
    v_mul_f32 v105, v105, v28
    v_mul_f32 v106, v106, v28
    v_mul_f32 v107, v107, v28
    v_mul_f32 v108, v108, v28
    v_mul_f32 v109, v109, v28
    v_mul_f32 v110, v110, v28
    v_mul_f32 v111, v111, v28
    v_mul_f32 v112, v112, v28
    v_mul_f32 v113, v113, v28
    v_mul_f32 v114, v114, v28
    v_mul_f32 v115, v115, v28
    v_mul_f32 v116, v116, v28
    v_mul_f32 v117, v117, v28
    v_mul_f32 v118, v118, v28
    v_mul_f32 v119, v119, v28
    v_mul_f32 v120, v120, v28
    v_mul_f32 v121, v121, v28
    v_mul_f32 v122, v122, v28
    v_mul_f32 v123, v123, v28
    v_mul_f32 v124, v124, v28
    v_mul_f32 v125, v125, v28
    v_mul_f32 v126, v126, v28
    v_mul_f32 v127, v127, v28
    s_nop 1
    s_branch L_pv_scaled
L_done:
L_exit:
    s_endpgm
.section .rodata,"a"
.p2align 6
.amdhsa_kernel recurrent_scan__compressed_kv_cla__dense_activation_gelu__decode_kernel
  .amdhsa_next_free_vgpr 256
  .amdhsa_next_free_sgpr 102
  .amdhsa_accum_offset 256
  .amdhsa_group_segment_fixed_size 0
  .amdhsa_kernarg_size 112
  .amdhsa_user_sgpr_count 2
  .amdhsa_user_sgpr_kernarg_segment_ptr 1
  .amdhsa_system_sgpr_workgroup_id_x 1
  .amdhsa_float_denorm_mode_32 3
.end_amdhsa_kernel
```
